```python
import torch

def _softmax(x, axis=-1):
    return torch.softmax(x, dim=axis)
def _gelu(x):
    return torch.nn.functional.gelu(x, approximate="tanh")
def _silu(x):
    return torch.nn.functional.silu(x)
def _sigmoid(x):
    return torch.sigmoid(x)
def _layernorm(x, axis=-1, eps=1e-5):
    m = x.mean(dim=axis, keepdim=True)
    v = x.var(dim=axis, keepdim=True, unbiased=False)
    return (x - m) / torch.sqrt(v + eps)
def _scatter_add(tgt, idx, src, axis=0):
    return tgt.clone().index_add_(axis, idx, src)
def _segment_sum(src, seg, n):
    out = torch.zeros((n,) + src.shape[1:], dtype=src.dtype)
    return out.index_add_(0, seg, src)
def _pad(x, pw):
    flat = tuple(v for pair in reversed(pw) for v in pair)
    return torch.nn.functional.pad(x, flat)

kernel_name = 'interleave_layers__ssm_conv_h3__sliding_block__prompt'

def setup_inputs():

    _w = (lambda a: (lambda t: t.to(torch.bfloat16) if t.is_floating_point() else t)(torch.as_tensor(a)))
    def _A_setup():
        B, S, D = 1, 2048, 448
        ks = 4
        return {
            "q": _w((lambda *s: torch.randn(*s, dtype=torch.bfloat16) * 0.05)(B, S, D)),
            "k": _w((lambda *s: torch.randn(*s, dtype=torch.bfloat16) * 0.4)(B, S, D)),
            "v": _w((lambda *s: torch.randn(*s, dtype=torch.bfloat16) * 0.4)(B, S, D)),
            "shift_k": _w((lambda *s: torch.randn(*s, dtype=torch.bfloat16) * 0.4)(D, ks) * 0.5),
            "ssm_k": _w((lambda *s: torch.randn(*s, dtype=torch.bfloat16) * 0.4)(D, S) * (1.0 / S ** 0.5)),
            "ssm_D": _w((lambda *s: torch.randn(*s, dtype=torch.bfloat16) * 0.4)(D)),
        }
    _A_in = _A_setup()

    def _B_setup():
        B, S, D = 1, 2048, 448
        return {
            "x": _w((lambda *s: torch.randn(*s, dtype=torch.bfloat16) * 0.05)(B, S, D)),
            "wqkv": _w((lambda *s: torch.randn(*s, dtype=torch.bfloat16) * 0.05)(D, 3 * D)),
            "wo": _w((lambda *s: torch.randn(*s, dtype=torch.bfloat16) * 0.05)(D, D)),
        }
    _B_in = _B_setup()

    return {
        "A_q": _A_in["q"],
        "A_k": _A_in["k"],
        "A_v": _A_in["v"],
        "A_shift_k": _A_in["shift_k"],
        "A_ssm_k": _A_in["ssm_k"],
        "A_ssm_D": _A_in["ssm_D"],
        "B_x": _B_in["x"],
        "B_wqkv": _B_in["wqkv"],
        "B_wo": _B_in["wo"],
    }

def reference(A_q, A_k, A_v, A_shift_k, A_ssm_k, A_ssm_D, B_x, B_wqkv, B_wo):
    def _A_ref(q, k, v, shift_k, ssm_k, ssm_D):
        B, S, D = q.shape
        ks = shift_k.shape[-1]
        k_pad = _pad(k, ((0, 0), (ks - 1, 0), (0, 0)))
        k_shift = torch.zeros_like(k)
        for t in range(ks):
            k_shift = k_shift + k_pad[:, t:t + S, :] * shift_k[:, ks - 1 - t][None, None, :]
        kv = k_shift * v
        L = 2 * S
        kv_pad = _pad(kv, ((0, 0), (0, S), (0, 0)))
        kf_pad = _pad(ssm_k, ((0, 0), (0, S)))
        kv_f = (lambda x, axes=(-2,-1): torch.fft.rfft2(x.float(), dim=axes))(kv_pad[:, None, :, :], axes=(1, 2))
        kf_f = (lambda x, axes=(-2,-1): torch.fft.rfft2(x.float(), dim=axes))(kf_pad[:, None, :], axes=(1, 2))
        kf_f = (lambda x, *d: x.permute(*d))(kf_f, 1, 2, 0)
        y_f = kv_f * kf_f[None, :, :, :]
        y = (lambda x, s, axes=(-2,-1): torch.fft.irfft2(x, s=s, dim=axes).to(torch.bfloat16))(y_f, (1, L), axes=(1, 2))[:, 0, :S, :]
        y = y + kv * ssm_D[None, None, :]
        return q * y

    def _B_ref(x, wqkv, wo):
        B, S, D = x.shape
        H = 16; Dh = D // H; W = 256
        qkv = (lambda x, *d: x.permute(*d))((x @ wqkv).reshape(B, S, 3, H, Dh), 2, 0, 3, 1, 4)
        q, k, v = qkv[0], qkv[1], qkv[2]
        scores = torch.einsum("bhqd,bhkd->bhqk", q, k) * (Dh ** -0.5)
        idx = torch.arange(S)
        mask = (idx[:, None] - idx[None, :] >= 0) & (idx[:, None] - idx[None, :] < W)
        scores = torch.where(mask[None, None], scores, -1e9)
        p = _softmax(scores, axis=-1)
        o = torch.einsum("bhqk,bhkd->bhqd", p, v)
        return (lambda x, *d: x.permute(*d))(o, 0, 2, 1, 3).reshape(B, S, D) @ wo

    x = A_q
    x = x + _A_ref(_layernorm(x, axis=-1), A_k, A_v, A_shift_k, A_ssm_k, A_ssm_D)
    x = x + _B_ref(_layernorm(x, axis=-1), B_wqkv, B_wo)
    x = x + _A_ref(_layernorm(x, axis=-1), A_k, A_v, A_shift_k, A_ssm_k, A_ssm_D)
    x = x + _B_ref(_layernorm(x, axis=-1), B_wqkv, B_wo)
    return x
```

```asm
; @launch kernel=kf_kernel grid=(256,1,1) block=(256,1,1) lds=108544
; @launch kernel=km_kernel grid=(256,1,1) block=(512,1,1) lds=163840
.amdgcn_target "amdgcn-amd-amdhsa--gfx950"
.text
.globl kf_kernel
.p2align 8
.type kf_kernel,@function
kf_kernel:
    s_cmp_ge_u32 s2, 256
    s_cbranch_scc1 L_kf_done
    s_load_dwordx8 s[4:11], s[0:1], 0
    s_load_dwordx4 s[12:15], s[0:1], 32
    s_load_dwordx4 s[16:19], s[0:1], 56
    s_load_dwordx4 s[68:71], s[0:1], 80
    s_memrealtime s[66:67]
    s_getpc_b64 s[44:45]
L_kf_pc0:
    s_mov_b32 s46, L_kf_done-L_kf_pc0
    s_mov_b32 s47, 0x20000
    v_lshlrev_b32 v1, 7, v0
    buffer_load_dword v175, v1, s[44:47], 0 offen
    v_lshrrev_b32 v1, 6, v0
    v_and_b32 v2, 63, v0
    v_readfirstlane_b32 s22, v1
    s_mov_b32 s23, 0x24924925
    s_mul_hi_u32 s48, s2, s23
    s_mul_i32 s49, s48, 7
    s_sub_u32 s49, s2, s49
    v_lshrrev_b32 v3, 3, v0
    v_and_b32 v4, 7, v0
    s_lshl_b32 s50, s48, 6
    v_lshl_add_u32 v5, v3, 1, s50
    s_movk_i32 s51, 896
    v_mul_lo_u32 v5, v5, s51
    s_lshl_b32 s52, s49, 7
    v_lshl_add_u32 v6, v4, 4, s52
    v_add_u32 v5, v5, v6
    v_subrev_u32 v7, 896, v5
    v_subrev_u32 v8, 1792, v5
    v_subrev_u32 v9, 2688, v5
    v_lshlrev_b32 v6, 2, v6
    v_mov_b32 v63, 0x40000000
    s_lshl_b32 s53, s2, 3
    s_lshl_b32 s54, s22, 1
    s_add_u32 s53, s53, s54
    s_mul_i32 s54, s53, 896
    v_lshlrev_b32 v60, 4, v2
    v_cmp_gt_u32 vcc, 56, v2
    v_add_u32 v61, s54, v60
    v_and_b32 v64, 15, v2
    v_lshrrev_b32 v65, 4, v2
    v_cndmask_b32 v61, v63, v61, vcc
    s_and_b32 s55, s2, 7
    s_mul_i32 s55, s55, 7
    s_lshr_b32 s57, s2, 5
    s_add_u32 s55, s55, s57
    s_bfe_u32 s57, s2, 0x20003
    s_lshr_b32 s58, s55, 2
    s_and_b32 s59, s55, 3
    s_lshl_b32 s56, s58, 5
    s_lshl_b32 s60, s59, 2
    s_add_u32 s56, s56, s60
    s_and_b32 s60, s57, 1
    s_lshl_b32 s60, s60, 1
    s_add_u32 s56, s56, s60
    s_lshr_b32 s60, s57, 1
    s_lshl_b32 s60, s60, 4
    s_add_u32 s56, s56, s60
    s_min_u32 s56, s56, 446
    s_lshl_b32 s60, s56, 1
    s_lshl_b32 s61, s56, 12
    v_lshlrev_b32 v11, 4, v0
    v_sub_u32 v12, 4064, v11
    v_add_u32 v12, s61, v12
    v_add_u32 v13, 16, v12
    s_waitcnt lgkmcnt(0)
    s_load_dword s62, s[14:15], s60
    s_mov_b32 s44, s68
    s_mov_b32 s45, s69
    s_mov_b32 s46, 256
    s_mov_b32 s47, 0x20000
    s_or_b32 s64, s2, s22
    s_cmp_lg_u32 s64, 0
    s_cbranch_scc1 L_kf_notag
    s_or_b32 s64, s66, 1
    v_mov_b32 v14, s64
    v_cmp_eq_u32 vcc, 0, v2
    s_nop 1
    v_cndmask_b32 v15, v63, 0, vcc
    buffer_store_dword v14, v15, s[44:47], 0 offen sc1
L_kf_notag:
    s_mov_b32 s24, s4
    s_mov_b32 s25, s5
    s_mov_b32 s26, 1835008
    s_mov_b32 s27, 0x20000
    s_mov_b32 s28, s6
    s_mov_b32 s29, s7
    s_mov_b32 s30, 1835008
    s_mov_b32 s31, 0x20000
    s_mov_b32 s32, s8
    s_mov_b32 s33, s9
    s_mov_b32 s34, 1835008
    s_mov_b32 s35, 0x20000
    s_mov_b32 s36, s10
    s_mov_b32 s37, s11
    s_mov_b32 s38, 3584
    s_mov_b32 s39, 0x20000
    s_mov_b32 s40, s70
    s_mov_b32 s41, s71
    s_mov_b32 s42, 32505856
    s_mov_b32 s43, 0x20000
    buffer_load_dwordx4 v[16:19], v9, s[28:31], 0 offen
    buffer_load_dwordx4 v[20:23], v8, s[28:31], 0 offen
    buffer_load_dwordx4 v[24:27], v7, s[28:31], 0 offen
    buffer_load_dwordx4 v[28:31], v5, s[28:31], 0 offen
    buffer_load_dwordx4 v[32:35], v5, s[32:35], 0 offen
    buffer_load_dwordx4 v[36:39], v6, s[36:39], 0 offen
    buffer_load_dwordx4 v[40:43], v6, s[36:39], 0 offen offset:16
    buffer_load_dwordx4 v[44:47], v6, s[36:39], 0 offen offset:32
    buffer_load_dwordx4 v[48:51], v6, s[36:39], 0 offen offset:48
    buffer_load_dwordx4 v[80:83], v5, s[28:31], 0 offen offset:896
    buffer_load_dwordx4 v[84:87], v5, s[32:35], 0 offen offset:896
    buffer_load_dwordx4 v[108:111], v5, s[24:27], 0 offen
    buffer_load_dwordx4 v[112:115], v5, s[24:27], 0 offen offset:896
    buffer_load_dwordx4 v[52:55], v61, s[24:27], 0 offen
    buffer_load_dwordx4 v[56:59], v61, s[24:27], 0 offen offset:896
    s_mov_b32 s24, s12
    s_mov_b32 s25, s13
    s_mov_b32 s26, 1835008
    s_mov_b32 s27, 0x20000
    s_mov_b32 s28, s16
    s_mov_b32 s29, s17
    s_mov_b32 s30, 1204224
    s_mov_b32 s31, 0x20000
    s_mov_b32 s32, s18
    s_mov_b32 s33, s19
    s_mov_b32 s34, 401408
    s_mov_b32 s35, 0x20000
    s_movk_i32 s63, 4096
    buffer_load_dwordx4 v[136:139], v12, s[24:27], 0 offen
    buffer_load_dwordx4 v[140:143], v13, s[24:27], 0 offen
    buffer_load_dwordx4 v[144:147], v12, s[24:27], s63 offen
    buffer_load_dwordx4 v[148:151], v13, s[24:27], s63 offen
    s_lshr_b32 s64, s2, 4
    s_and_b32 s65, s2, 15
    s_movk_i32 s4, 2688
    v_mul_lo_u32 v14, v3, s4
    v_lshl_add_u32 v14, v4, 3, v14
    v_cmp_gt_u32 vcc, 7, v4
    v_mul_lo_u32 v15, v3, s51
    v_lshl_add_u32 v15, v4, 3, v15
    v_cndmask_b32 v14, v63, v14, vcc
    v_cmp_gt_u32 s[20:21], 28, v3
    s_mul_i32 s5, s64, 86016
    s_mul_i32 s6, s65, 56
    s_add_u32 s5, s5, s6
    v_cndmask_b32 v15, v63, v15, s[20:21]
    s_mul_i32 s6, s65, 25088
    s_lshl_b32 s7, s64, 6
    s_add_u32 s6, s6, s7
    s_cmp_ge_u32 s2, 224
    s_cselect_b32 s5, 0, s5
    s_cselect_b32 s6, 0, s6
    s_cselect_b32 s11, 0x40000000, 0
    buffer_load_dwordx2 v[88:89], v14, s[28:31], s5 offen
    buffer_load_dwordx2 v[90:91], v14, s[28:31], s5 offen offset:896
    buffer_load_dwordx2 v[92:93], v14, s[28:31], s5 offen offset:1792
    buffer_load_dwordx2 v[94:95], v15, s[32:35], s6 offen
    v_cmp_eq_u32 s[20:21], 7, v4
    v_lshlrev_b32 v96, 8, v3
    v_lshl_add_u32 v96, v4, 3, v96
    v_add_u32 v96, 92160, v96
    s_mov_b32 s4, 0xffff0000
    s_mov_b32 s5, 0x01000504
    s_mov_b32 s6, 0x03020706
    v_mov_b32 v62, 0x3f803f80
    v_lshlrev_b32 v14, 8, v3
    v_lshl_add_u32 v14, v4, 4, v14
    v_add_u32 v14, 75776, v14
    v_lshrrev_b32 v152, 2, v64
    v_lshl_add_u32 v152, v65, 3, v152
    v_lshlrev_b32 v152, 7, v152
    v_and_b32 v153, 3, v64
    v_lshl_add_u32 v152, v153, 3, v152
    s_lshl_b32 s7, s22, 5
    s_add_u32 s7, s7, 75776
    v_add_u32 v152, s7, v152
    s_lshl_b32 s7, s22, 11
    s_add_u32 s7, s7, 100352
    v_lshlrev_b32 v153, 7, v64
    v_lshl_add_u32 v153, v65, 4, v153
    v_add_u32 v153, s7, v153
    v_add_u32 v154, s7, v60
    s_lshl_b32 s7, s49, 6
    s_lshl_b32 s8, s22, 4
    s_add_u32 s7, s7, s8
    v_lshrrev_b32 v155, 3, v2
    v_add_u32 v155, s7, v155
    s_movk_i32 s8, 4224
    v_mul_lo_u32 v155, v155, s8
    v_lshl_add_u32 v155, v4, 4, v155
    v_or_b32 v155, s11, v155
    s_lshl_b32 s7, s48, 7
    s_add_u32 s7, s7, 0
    s_add_u32 s10, s7, 33792
    v_lshlrev_b32 v156, 9, v4
    v_lshl_add_u32 v156, v3, 2, v156
    v_add_u32 v156, 83968, v156
    s_lshl_b32 s9, s49, 5
    v_add_u32 v157, s9, v3
    s_movk_i32 s9, 8320
    v_mul_lo_u32 v157, v157, s9
    v_lshl_add_u32 v157, v4, 4, v157
    v_or_b32 v157, s11, v157
    s_lshl_b32 s8, s48, 8
    s_add_u32 s8, s8, 2097152
    v_mov_b32 v120, 0
    v_mov_b32 v121, 0
    v_mov_b32 v122, 0
    v_mov_b32 v123, 0
    s_mov_b32 s9, 37888
    v_bfe_u32 v9, v0, 5, 1
    v_mul_lo_u32 v9, v9, s9
    v_and_b32 v10, 31, v0
    v_lshl_add_u32 v9, v10, 4, v9
    ds_write_b128 v9, v[120:123]
    v_bfe_u32 v9, v0, 3, 1
    v_mul_lo_u32 v9, v9, s9
    s_movk_i32 s9, 4160
    v_mul_lo_u32 v10, v4, s9
    v_add_u32 v9, v9, v10
    ds_write_b128 v9, v[120:123] offset:8736
    s_waitcnt vmcnt(14)
    v_perm_b32 v124, v28, v24, s5
    v_perm_b32 v125, v28, v24, s6
    v_perm_b32 v126, v20, v16, s5
    v_perm_b32 v127, v20, v16, s6
    v_dot2_f32_bf16 v124, v124, v36, 0
    v_dot2_f32_bf16 v125, v125, v38, 0
    v_dot2_f32_bf16 v124, v126, v37, v124
    v_dot2_f32_bf16 v125, v127, v39, v125
    v_lshlrev_b32 v128, 16, v32
    v_and_b32 v129, s4, v32
    s_nop 0
    v_mul_f32 v124, v124, v128
    v_mul_f32 v125, v125, v129
    v_cvt_pk_bf16_f32 v160, v124, v125
    v_perm_b32 v130, v29, v25, s5
    v_perm_b32 v131, v29, v25, s6
    v_perm_b32 v132, v21, v17, s5
    v_perm_b32 v133, v21, v17, s6
    v_dot2_f32_bf16 v130, v130, v40, 0
    v_dot2_f32_bf16 v131, v131, v42, 0
    v_dot2_f32_bf16 v130, v132, v41, v130
    v_dot2_f32_bf16 v131, v133, v43, v131
    v_lshlrev_b32 v134, 16, v33
    v_and_b32 v135, s4, v33
    s_nop 0
    v_mul_f32 v130, v130, v134
    v_mul_f32 v131, v131, v135
    v_cvt_pk_bf16_f32 v161, v130, v131
    v_perm_b32 v124, v30, v26, s5
    v_perm_b32 v125, v30, v26, s6
    v_perm_b32 v126, v22, v18, s5
    v_perm_b32 v127, v22, v18, s6
    v_dot2_f32_bf16 v124, v124, v44, 0
    v_dot2_f32_bf16 v125, v125, v46, 0
    v_dot2_f32_bf16 v124, v126, v45, v124
    v_dot2_f32_bf16 v125, v127, v47, v125
    v_lshlrev_b32 v128, 16, v34
    v_and_b32 v129, s4, v34
    s_nop 0
    v_mul_f32 v124, v124, v128
    v_mul_f32 v125, v125, v129
    v_cvt_pk_bf16_f32 v162, v124, v125
    v_perm_b32 v130, v31, v27, s5
    v_perm_b32 v131, v31, v27, s6
    v_perm_b32 v132, v23, v19, s5
    v_perm_b32 v133, v23, v19, s6
    v_dot2_f32_bf16 v130, v130, v48, 0
    v_dot2_f32_bf16 v131, v131, v50, 0
    v_dot2_f32_bf16 v130, v132, v49, v130
    v_dot2_f32_bf16 v131, v133, v51, v131
    v_lshlrev_b32 v134, 16, v35
    v_and_b32 v135, s4, v35
    s_nop 0
    v_mul_f32 v130, v130, v134
    v_mul_f32 v131, v131, v135
    v_cvt_pk_bf16_f32 v163, v130, v131
    ds_write_b128 v14, v[160:163] offset:0
    s_waitcnt vmcnt(12)
    v_perm_b32 v124, v80, v28, s5
    v_perm_b32 v125, v80, v28, s6
    v_perm_b32 v126, v24, v20, s5
    v_perm_b32 v127, v24, v20, s6
    v_dot2_f32_bf16 v124, v124, v36, 0
    v_dot2_f32_bf16 v125, v125, v38, 0
    v_dot2_f32_bf16 v124, v126, v37, v124
    v_dot2_f32_bf16 v125, v127, v39, v125
    v_lshlrev_b32 v128, 16, v84
    v_and_b32 v129, s4, v84
    s_nop 0
    v_mul_f32 v124, v124, v128
    v_mul_f32 v125, v125, v129
    v_cvt_pk_bf16_f32 v164, v124, v125
    v_perm_b32 v130, v81, v29, s5
    v_perm_b32 v131, v81, v29, s6
    v_perm_b32 v132, v25, v21, s5
    v_perm_b32 v133, v25, v21, s6
    v_dot2_f32_bf16 v130, v130, v40, 0
    v_dot2_f32_bf16 v131, v131, v42, 0
    v_dot2_f32_bf16 v130, v132, v41, v130
    v_dot2_f32_bf16 v131, v133, v43, v131
    v_lshlrev_b32 v134, 16, v85
    v_and_b32 v135, s4, v85
    s_nop 0
    v_mul_f32 v130, v130, v134
    v_mul_f32 v131, v131, v135
    v_cvt_pk_bf16_f32 v165, v130, v131
    v_perm_b32 v124, v82, v30, s5
    v_perm_b32 v125, v82, v30, s6
    v_perm_b32 v126, v26, v22, s5
    v_perm_b32 v127, v26, v22, s6
    v_dot2_f32_bf16 v124, v124, v44, 0
    v_dot2_f32_bf16 v125, v125, v46, 0
    v_dot2_f32_bf16 v124, v126, v45, v124
    v_dot2_f32_bf16 v125, v127, v47, v125
    v_lshlrev_b32 v128, 16, v86
    v_and_b32 v129, s4, v86
    s_nop 0
    v_mul_f32 v124, v124, v128
    v_mul_f32 v125, v125, v129
    v_cvt_pk_bf16_f32 v166, v124, v125
    v_perm_b32 v130, v83, v31, s5
    v_perm_b32 v131, v83, v31, s6
    v_perm_b32 v132, v27, v23, s5
    v_perm_b32 v133, v27, v23, s6
    v_dot2_f32_bf16 v130, v130, v48, 0
    v_dot2_f32_bf16 v131, v131, v50, 0
    v_dot2_f32_bf16 v130, v132, v49, v130
    v_dot2_f32_bf16 v131, v133, v51, v131
    v_lshlrev_b32 v134, 16, v87
    v_and_b32 v135, s4, v87
    s_nop 0
    v_mul_f32 v130, v130, v134
    v_mul_f32 v131, v131, v135
    v_cvt_pk_bf16_f32 v167, v130, v131
    ds_write_b128 v14, v[164:167] offset:128
    s_waitcnt vmcnt(10)
    ds_write_b128 v14, v[108:111] offset:8192
    ds_write_b128 v14, v[112:115] offset:8320
    v_mov_b32 v158, 0
    buffer_load_dword v159, v158, s[44:47], 0 offen sc1
    s_waitcnt lgkmcnt(0)
    s_barrier
    ds_read_b64_tr_b16 v[16:17], v152
    ds_read_b64_tr_b16 v[18:19], v152 offset:512
    ds_read_b64_tr_b16 v[20:21], v152 offset:4096
    ds_read_b64_tr_b16 v[22:23], v152 offset:4608
    ds_read_b32 v24, v156 offset:0
    ds_read_b32 v25, v156 offset:128
    ds_read_b32 v26, v156 offset:256
    ds_read_b32 v27, v156 offset:384
    ds_read_b32 v28, v156 offset:4096
    ds_read_b32 v29, v156 offset:4224
    ds_read_b32 v30, v156 offset:4352
    ds_read_b32 v31, v156 offset:4480
    s_waitcnt lgkmcnt(8)
    ds_write_b128 v153, v[16:19]
    ds_write_b128 v153, v[20:23] offset:64
    ds_read_b128 v[32:35], v154
    ds_read_b128 v[36:39], v154 offset:1024
    s_waitcnt lgkmcnt(4)
    buffer_store_dwordx4 v[24:27], v157, s[40:43], s8 offen sc1
    buffer_store_dwordx4 v[28:31], v157, s[40:43], s8 offen offset:128 sc1
    s_waitcnt lgkmcnt(0)
    buffer_store_dwordx4 v[32:35], v155, s[40:43], s7 offen sc1
    buffer_store_dwordx4 v[36:39], v155, s[40:43], s10 offen sc1
    s_waitcnt vmcnt(5)
    v_dot2_f32_bf16 v165, v52, v62, 0
    v_dot2_f32_bf16 v164, v52, v52, 0
    v_dot2_f32_bf16 v165, v53, v62, v165
    v_dot2_f32_bf16 v164, v53, v53, v164
    v_dot2_f32_bf16 v165, v54, v62, v165
    v_dot2_f32_bf16 v164, v54, v54, v164
    v_dot2_f32_bf16 v165, v55, v62, v165
    v_dot2_f32_bf16 v164, v55, v55, v164
    v_dot2_f32_bf16 v169, v56, v62, 0
    v_dot2_f32_bf16 v168, v56, v56, 0
    v_dot2_f32_bf16 v169, v57, v62, v169
    v_dot2_f32_bf16 v168, v57, v57, v168
    v_dot2_f32_bf16 v169, v58, v62, v169
    v_dot2_f32_bf16 v168, v58, v58, v168
    v_dot2_f32_bf16 v169, v59, v62, v169
    v_dot2_f32_bf16 v168, v59, v59, v168
    v_mov_b32 v97, 0x3f80
    v_cndmask_b32 v90, v90, v97, s[20:21]
    ds_write_b64 v96, v[88:89]
    ds_write_b64 v96, v[90:91] offset:64
    ds_write_b64 v96, v[92:93] offset:128
    ds_write_b64 v96, v[94:95] offset:192
    v_add_f32_dpp v164, v164, v164 row_shr:1 row_mask:0xf bank_mask:0xf bound_ctrl:0
    v_add_f32_dpp v165, v165, v165 row_shr:1 row_mask:0xf bank_mask:0xf bound_ctrl:0
    v_add_f32_dpp v168, v168, v168 row_shr:1 row_mask:0xf bank_mask:0xf bound_ctrl:0
    v_add_f32_dpp v169, v169, v169 row_shr:1 row_mask:0xf bank_mask:0xf bound_ctrl:0
    v_add_f32_dpp v164, v164, v164 row_shr:2 row_mask:0xf bank_mask:0xf bound_ctrl:0
    v_add_f32_dpp v165, v165, v165 row_shr:2 row_mask:0xf bank_mask:0xf bound_ctrl:0
    v_add_f32_dpp v168, v168, v168 row_shr:2 row_mask:0xf bank_mask:0xf bound_ctrl:0
    v_add_f32_dpp v169, v169, v169 row_shr:2 row_mask:0xf bank_mask:0xf bound_ctrl:0
    v_add_f32_dpp v164, v164, v164 row_shr:4 row_mask:0xf bank_mask:0xf bound_ctrl:0
    v_add_f32_dpp v165, v165, v165 row_shr:4 row_mask:0xf bank_mask:0xf bound_ctrl:0
    v_add_f32_dpp v168, v168, v168 row_shr:4 row_mask:0xf bank_mask:0xf bound_ctrl:0
    v_add_f32_dpp v169, v169, v169 row_shr:4 row_mask:0xf bank_mask:0xf bound_ctrl:0
    v_add_f32_dpp v164, v164, v164 row_shr:8 row_mask:0xf bank_mask:0xf bound_ctrl:0
    v_add_f32_dpp v165, v165, v165 row_shr:8 row_mask:0xf bank_mask:0xf bound_ctrl:0
    v_add_f32_dpp v168, v168, v168 row_shr:8 row_mask:0xf bank_mask:0xf bound_ctrl:0
    v_add_f32_dpp v169, v169, v169 row_shr:8 row_mask:0xf bank_mask:0xf bound_ctrl:0
    v_add_f32_dpp v164, v164, v164 row_bcast:15 row_mask:0xa bank_mask:0xf
    v_add_f32_dpp v165, v165, v165 row_bcast:15 row_mask:0xa bank_mask:0xf
    v_add_f32_dpp v168, v168, v168 row_bcast:15 row_mask:0xa bank_mask:0xf
    v_add_f32_dpp v169, v169, v169 row_bcast:15 row_mask:0xa bank_mask:0xf
    v_add_f32_dpp v164, v164, v164 row_bcast:31 row_mask:0xc bank_mask:0xf
    v_add_f32_dpp v165, v165, v165 row_bcast:31 row_mask:0xc bank_mask:0xf
    v_add_f32_dpp v168, v168, v168 row_bcast:31 row_mask:0xc bank_mask:0xf
    v_add_f32_dpp v169, v169, v169 row_bcast:31 row_mask:0xc bank_mask:0xf
    v_mul_f32 v165, 0x3b124925, v165
    v_mul_f32 v164, 0x3b124925, v164
    v_fma_f32 v164, -v165, v165, v164
    v_max_f32 v164, 0, v164
    v_add_f32 v164, 0x3727c5ac, v164
    v_rsq_f32 v164, v164
    s_nop 0
    v_mul_f32 v165, v165, v164
    v_sub_f32 v165, 0, v165
    v_mul_f32 v169, 0x3b124925, v169
    v_mul_f32 v168, 0x3b124925, v168
    v_fma_f32 v168, -v169, v169, v168
    v_max_f32 v168, 0, v168
    v_add_f32 v168, 0x3727c5ac, v168
    v_rsq_f32 v168, v168
    s_nop 0
    v_mul_f32 v169, v169, v168
    v_sub_f32 v169, 0, v169
    s_mov_b32 s3, 0
    s_waitcnt vmcnt(4)
L_kf_tag:
    v_readfirstlane_b32 s54, v159
    s_add_u32 s3, s3, 1
    s_cmp_gt_u32 s3, 0x80000
    s_cbranch_scc1 L_kf_tagok
    s_cmp_lg_u32 s54, 0
    s_cbranch_scc1 L_kf_tagok
    buffer_load_dword v159, v158, s[44:47], 0 offen sc1
    s_waitcnt vmcnt(0)
    s_branch L_kf_tag
L_kf_tagok:
    v_mov_b32 v166, s54
    v_mov_b32 v167, s54
    v_mov_b32 v170, s54
    v_mov_b32 v171, s54
    v_cmp_eq_u32 vcc, 63, v2
    s_lshl_b32 s9, s53, 4
    s_add_u32 s9, s9, 4194304
    v_cndmask_b32 v158, v63, 0, vcc
    buffer_store_dwordx4 v[164:167], v158, s[40:43], s9 offen sc1
    buffer_store_dwordx4 v[168:171], v158, s[40:43], s9 offen offset:16 sc1
    s_waitcnt vmcnt(2) lgkmcnt(0)
    s_barrier
    s_cmp_lg_u32 s22, 3
    s_cbranch_scc1 L_kf_nofl
    s_lshl_b32 s50, s2, 7
    s_add_u32 s50, s50, 7077888
    buffer_store_dword v166, v158, s[40:43], s50 offen sc1
L_kf_nofl:
    v_lshrrev_b32 v96, 2, v64
    v_lshl_add_u32 v96, v65, 2, v96
    v_lshlrev_b32 v96, 8, v96
    v_and_b32 v97, 3, v64
    v_lshl_add_u32 v96, v97, 3, v96
    s_lshl_b32 s3, s22, 5
    s_add_u32 s3, s3, 92160
    v_add_u32 v96, s3, v96
    ds_read_b64_tr_b16 v[100:101], v96
    ds_read_b64_tr_b16 v[102:103], v96 offset:4096
    ds_read_b64_tr_b16 v[104:105], v96 offset:128
    ds_read_b64_tr_b16 v[106:107], v96 offset:4224
    s_mul_i32 s3, s65, 6
    s_add_u32 s3, s3, s22
    s_mul_i32 s3, s3, 14
    s_add_u32 s3, s3, s64
    s_lshl_b32 s3, s3, 10
    s_add_u32 s3, s3, 7340032
    s_add_u32 s4, s3, 57344
    s_lshl_b32 s5, s64, 1
    s_add_u32 s5, s5, s22
    s_sub_u32 s5, s5, 2
    s_lshl_b32 s5, s5, 4
    s_add_u32 s5, s5, s65
    s_lshl_b32 s5, s5, 10
    s_add_u32 s5, s5, 8716288
    s_cmp_ge_u32 s22, 2
    s_cselect_b32 s4, s5, s4
    v_or_b32 v97, s11, v60
    s_waitcnt lgkmcnt(0)
    buffer_store_dwordx4 v[100:103], v97, s[40:43], s3 offen sc1
    buffer_store_dwordx4 v[104:107], v97, s[40:43], s4 offen sc1
    v_dot2_f32_bf16 v108, v100, v62, 0
    v_dot2_f32_bf16 v109, v104, v62, 0
    v_dot2_f32_bf16 v108, v101, v62, v108
    v_dot2_f32_bf16 v109, v105, v62, v109
    v_dot2_f32_bf16 v108, v102, v62, v108
    v_dot2_f32_bf16 v109, v106, v62, v109
    v_dot2_f32_bf16 v108, v103, v62, v108
    v_dot2_f32_bf16 v109, v107, v62, v109
    s_sub_u32 s3, s3, 7340032
    s_lshr_b32 s3, s3, 4
    s_add_u32 s3, s3, 5242880
    s_cmp_ge_u32 s22, 2
    s_cselect_b32 s5, 0x40000000, s11
    v_mov_b32 v110, v108
    v_mov_b32 v111, v109
    s_nop 1
    v_permlane16_swap_b32 v108, v110
    v_permlane16_swap_b32 v109, v111
    s_nop 1
    v_add_f32 v108, v108, v110
    v_add_f32 v109, v109, v111
    v_mov_b32 v110, v108
    v_mov_b32 v111, v109
    s_nop 1
    v_permlane32_swap_b32 v108, v110
    v_permlane32_swap_b32 v109, v111
    s_nop 1
    v_add_f32 v108, v108, v110
    v_add_f32 v109, v109, v111
    v_lshlrev_b32 v96, 2, v64
    v_or_b32 v97, s5, v96
    v_or_b32 v96, s11, v96
    buffer_store_dword v108, v96, s[40:43], s3 offen
    buffer_store_dword v109, v97, s[40:43], s3 offen offset:3584
    s_cmp_lg_u32 s22, 0
    s_cbranch_scc1 L_kf_misce
    v_mov_b32 v92, -1
    v_mov_b32 v93, -1
    v_mov_b32 v94, -1
    v_mov_b32 v95, -1
    s_lshl_b32 s3, s2, 10
    s_add_u32 s3, s3, 6356992
    buffer_store_dwordx4 v[92:95], v60, s[40:43], s3 offen
    v_cmp_gt_u32 vcc, 6, v2
    v_lshlrev_b32 v90, 15, v2
    s_lshl_b32 s3, s2, 7
    s_add_u32 s3, s3, 6815744
    v_cndmask_b32 v90, v63, v90, vcc
    buffer_store_dword v120, v90, s[40:43], s3 offen
L_kf_misce:
    s_cmp_ge_u32 s2, 224
    s_cbranch_scc1 L_kf_pf
    v_add_u32 v12, 37888, v11
    v_cmp_eq_u32 vcc, 255, v0
    v_mov_b32 v13, 0xffff
    s_nop 0
    v_cndmask_b32 v136, v136, v120, vcc
    v_cndmask_b32 v137, v137, v120, vcc
    v_cndmask_b32 v138, v138, v120, vcc
    v_cndmask_b32 v139, v139, v120, vcc
    v_alignbit_b32 v124, v143, v143, 16
    v_alignbit_b32 v125, v142, v142, 16
    v_alignbit_b32 v126, v141, v141, 16
    v_alignbit_b32 v127, v140, v140, 16
    ds_write_b128 v11, v[124:127] offset:4640
    v_bfi_b32 v128, v13, v143, v142
    v_bfi_b32 v129, v13, v142, v141
    v_bfi_b32 v130, v13, v141, v140
    v_bfi_b32 v131, v13, v140, v139
    ds_write_b128 v11, v[128:131] offset:8800
    v_alignbit_b32 v124, v142, v142, 16
    v_alignbit_b32 v125, v141, v141, 16
    v_alignbit_b32 v126, v140, v140, 16
    v_alignbit_b32 v127, v139, v139, 16
    ds_write_b128 v11, v[124:127] offset:12960
    v_bfi_b32 v128, v13, v142, v141
    v_bfi_b32 v129, v13, v141, v140
    v_bfi_b32 v130, v13, v140, v139
    v_bfi_b32 v131, v13, v139, v138
    ds_write_b128 v11, v[128:131] offset:17120
    v_alignbit_b32 v124, v141, v141, 16
    v_alignbit_b32 v125, v140, v140, 16
    v_alignbit_b32 v126, v139, v139, 16
    v_alignbit_b32 v127, v138, v138, 16
    ds_write_b128 v11, v[124:127] offset:21280
    v_bfi_b32 v128, v13, v141, v140
    v_bfi_b32 v129, v13, v140, v139
    v_bfi_b32 v130, v13, v139, v138
    v_bfi_b32 v131, v13, v138, v137
    ds_write_b128 v11, v[128:131] offset:25440
    v_alignbit_b32 v124, v140, v140, 16
    v_alignbit_b32 v125, v139, v139, 16
    v_alignbit_b32 v126, v138, v138, 16
    v_alignbit_b32 v127, v137, v137, 16
    ds_write_b128 v11, v[124:127] offset:29600
    v_bfi_b32 v128, v13, v140, v139
    v_bfi_b32 v129, v13, v139, v138
    v_bfi_b32 v130, v13, v138, v137
    v_bfi_b32 v131, v13, v137, v136
    ds_write_b128 v11, v[128:131] offset:33760
    v_cndmask_b32 v144, v144, v120, vcc
    v_cndmask_b32 v145, v145, v120, vcc
    v_cndmask_b32 v146, v146, v120, vcc
    v_cndmask_b32 v147, v147, v120, vcc
    v_alignbit_b32 v124, v151, v151, 16
    v_alignbit_b32 v125, v150, v150, 16
    v_alignbit_b32 v126, v149, v149, 16
    v_alignbit_b32 v127, v148, v148, 16
    ds_write_b128 v12, v[124:127] offset:4640
    v_bfi_b32 v128, v13, v151, v150
    v_bfi_b32 v129, v13, v150, v149
    v_bfi_b32 v130, v13, v149, v148
    v_bfi_b32 v131, v13, v148, v147
    ds_write_b128 v12, v[128:131] offset:8800
    v_alignbit_b32 v124, v150, v150, 16
    v_alignbit_b32 v125, v149, v149, 16
    v_alignbit_b32 v126, v148, v148, 16
    v_alignbit_b32 v127, v147, v147, 16
    ds_write_b128 v12, v[124:127] offset:12960
    v_bfi_b32 v128, v13, v150, v149
    v_bfi_b32 v129, v13, v149, v148
    v_bfi_b32 v130, v13, v148, v147
    v_bfi_b32 v131, v13, v147, v146
    ds_write_b128 v12, v[128:131] offset:17120
    v_alignbit_b32 v124, v149, v149, 16
    v_alignbit_b32 v125, v148, v148, 16
    v_alignbit_b32 v126, v147, v147, 16
    v_alignbit_b32 v127, v146, v146, 16
    ds_write_b128 v12, v[124:127] offset:21280
    v_bfi_b32 v128, v13, v149, v148
    v_bfi_b32 v129, v13, v148, v147
    v_bfi_b32 v130, v13, v147, v146
    v_bfi_b32 v131, v13, v146, v145
    ds_write_b128 v12, v[128:131] offset:25440
    v_alignbit_b32 v124, v148, v148, 16
    v_alignbit_b32 v125, v147, v147, 16
    v_alignbit_b32 v126, v146, v146, 16
    v_alignbit_b32 v127, v145, v145, 16
    ds_write_b128 v12, v[124:127] offset:29600
    v_bfi_b32 v128, v13, v148, v147
    v_bfi_b32 v129, v13, v147, v146
    v_bfi_b32 v130, v13, v146, v145
    v_bfi_b32 v131, v13, v145, v144
    ds_write_b128 v12, v[128:131] offset:33760
    s_lshr_b32 s23, s22, 1
    s_and_b32 s33, s22, 1
    s_mul_i32 s36, s23, 37888
    s_lshl_b32 s37, s33, 11
    s_add_u32 s38, s36, s37
    s_add_u32 s38, s38, 512
    s_add_u32 s39, s56, s23
    s_mul_i32 s39, s39, 4224
    s_add_u32 s39, s39, s37
    s_add_u32 s39, s39, 0
    s_movk_i32 s7, 4160
    v_and_b32 v10, 7, v64
    v_sub_u32 v10, 7, v10
    v_mul_lo_u32 v10, v10, s7
    v_lshrrev_b32 v12, 3, v64
    v_sub_u32 v12, v65, v12
    v_lshl_add_u32 v10, v12, 4, v10
    s_add_u32 s7, s36, 4656
    v_add_u32 v10, s7, v10
    v_lshlrev_b32 v12, 5, v64
    v_lshl_add_u32 v12, v65, 4, v12
    s_add_u32 s7, s36, 32
    v_add_u32 v12, s7, v12
    s_mov_b32 s7, 57344
    v_mul_lo_u32 v7, v65, s7
    v_lshl_add_u32 v7, v64, 4, v7
    s_mul_i32 s52, s22, 458752
    s_lshl_b32 s7, s58, 10
    s_add_u32 s52, s52, s7
    s_lshl_b32 s7, s59, 8
    s_add_u32 s52, s52, s7
    s_lshl_b32 s7, s57, 2
    s_add_u32 s52, s52, s7
    s_lshl_b32 s7, s22, 13
    s_add_u32 s7, s7, 75776
    v_add_u32 v13, s7, v60
    s_lshl_b32 s7, s22, 11
    v_lshlrev_b32 v66, 8, v65
    v_lshl_add_u32 v66, v64, 2, v66
    v_add_u32 v66, s7, v66
    v_lshlrev_b32 v67, 2, v66
    s_add_u32 s7, s7, 75776
    v_add_u32 v14, s7, v60
    s_lshr_b32 s8, s56, 1
    s_mul_i32 s8, s8, 8320
    s_add_u32 s55, s8, 9437184
    s_add_u32 s8, s8, 2097152
    s_mov_b32 s9, 4194304
    s_mov_b32 s10, 4198400
    v_and_b32 v40, 31, v2
    v_mul_u32_u24 v40, 7, v40
    s_lshr_b32 s3, s56, 6
    v_add_u32 v40, s3, v40
    v_lshlrev_b32 v40, 7, v40
    s_mov_b32 s3, 0
    s_mov_b32 s7, 7077888
    s_mov_b32 m0, s38
L_kf_poll:
    buffer_load_dword v41, v40, s[40:43], s7 offen sc1
    s_add_u32 s3, s3, 1
    s_waitcnt vmcnt(0)
    v_cmp_ne_u32 vcc, s54, v41
    s_cmp_gt_u32 s3, 0x80000
    s_cbranch_scc1 L_kf_pd
    s_cbranch_vccz L_kf_pd
    s_sleep 1
    s_branch L_kf_poll
L_kf_pd:
    buffer_load_dwordx4 v60, s[40:43], s39 offen sc1 lds
    buffer_load_dwordx4 v60, s[40:43], s39 offen offset:1024 sc1 lds
    buffer_load_dword v68, v66, s[40:43], s8 offen offset:0 sc1
    buffer_load_dword v69, v66, s[40:43], s8 offen offset:64 sc1
    buffer_load_dword v70, v66, s[40:43], s8 offen offset:128 sc1
    buffer_load_dword v71, v66, s[40:43], s8 offen offset:192 sc1
    buffer_load_dword v72, v66, s[40:43], s8 offen offset:1024 sc1
    buffer_load_dword v73, v66, s[40:43], s8 offen offset:1088 sc1
    buffer_load_dword v74, v66, s[40:43], s8 offen offset:1152 sc1
    buffer_load_dword v75, v66, s[40:43], s8 offen offset:1216 sc1
    buffer_load_dwordx4 v[124:127], v67, s[40:43], s9 offen offset:0 sc1
    buffer_load_dwordx4 v[128:131], v67, s[40:43], s9 offen offset:256 sc1
    buffer_load_dwordx4 v[132:135], v67, s[40:43], s9 offen offset:512 sc1
    buffer_load_dwordx4 v[136:139], v67, s[40:43], s9 offen offset:768 sc1
    buffer_load_dwordx4 v[140:143], v67, s[40:43], s10 offen offset:0 sc1
    buffer_load_dwordx4 v[144:147], v67, s[40:43], s10 offen offset:256 sc1
    buffer_load_dwordx4 v[148:151], v67, s[40:43], s10 offen offset:512 sc1
    buffer_load_dwordx4 v[152:155], v67, s[40:43], s10 offen offset:768 sc1
    s_waitcnt vmcnt(16) lgkmcnt(0)
    s_barrier
    s_cmp_eq_u32 s33, 1
    s_cbranch_scc1 L_kf_w1
    ds_read_b128 v[16:19], v10 offset:4032
    ds_read_b128 a[252:255], v12 offset:4032
    ds_read_b128 a[220:223], v12 offset:3520
    ds_read_b128 a[188:191], v12 offset:3008
    ds_read_b128 a[156:159], v12 offset:2496
    ds_read_b128 a[124:127], v12 offset:1984
    ds_read_b128 a[92:95], v12 offset:1472
    ds_read_b128 a[60:63], v12 offset:960
    ds_read_b128 a[28:31], v12 offset:448
    ds_read_b128 v[20:23], v10 offset:3968
    ds_read_b128 a[248:251], v12 offset:3968
    ds_read_b128 a[216:219], v12 offset:3456
    ds_read_b128 a[184:187], v12 offset:2944
    ds_read_b128 a[152:155], v12 offset:2432
    ds_read_b128 a[120:123], v12 offset:1920
    ds_read_b128 a[88:91], v12 offset:1408
    ds_read_b128 a[56:59], v12 offset:896
    ds_read_b128 a[24:27], v12 offset:384
    s_lshl_b32 s7, s23, 4
    s_lshr_b32 s7, s62, s7
    s_and_b32 s7, s7, 0xffff
    s_lshl_b32 s8, s7, 16
    v_and_b32 v36, 1, v64
    v_cmp_eq_u32 vcc, 1, v36
    v_mov_b32 v37, s7
    v_mov_b32 v38, s8
    v_lshlrev_b32 v36, 2, v65
    v_cndmask_b32 v37, v37, v38, vcc
    v_lshrrev_b32 v38, 1, v64
    v_add_u32 v38, 8, v38
    v_sub_u32 v38, v38, v36
    v_cmp_eq_u32 s[12:13], 0, v38
    v_cmp_eq_u32 s[14:15], 1, v38
    v_cmp_eq_u32 s[16:17], 2, v38
    v_cmp_eq_u32 s[18:19], 3, v38
    s_nop 1
    v_cndmask_b32 v32, 0, v37, s[12:13]
    v_cndmask_b32 v33, 0, v37, s[14:15]
    v_cndmask_b32 v34, 0, v37, s[16:17]
    v_cndmask_b32 v35, 0, v37, s[18:19]
    ds_read_b128 v[24:27], v10 offset:3904
    ds_read_b128 a[244:247], v12 offset:3904
    ds_read_b128 a[212:215], v12 offset:3392
    ds_read_b128 a[180:183], v12 offset:2880
    ds_read_b128 a[148:151], v12 offset:2368
    ds_read_b128 a[116:119], v12 offset:1856
    ds_read_b128 a[84:87], v12 offset:1344
    ds_read_b128 a[52:55], v12 offset:832
    ds_read_b128 a[20:23], v12 offset:320
    s_waitcnt lgkmcnt(15)
    v_mfma_f32_16x16x32_bf16 v[116:119], a[252:255], v[16:19], 0
    v_mfma_f32_16x16x32_bf16 v[112:115], a[220:223], v[16:19], 0
    v_mfma_f32_16x16x32_bf16 v[108:111], a[188:191], v[16:19], 0
    v_mfma_f32_16x16x32_bf16 v[104:107], a[156:159], v[16:19], 0
    v_mfma_f32_16x16x32_bf16 v[100:103], a[124:127], v[16:19], 0
    v_mfma_f32_16x16x32_bf16 v[96:99], a[92:95], v[16:19], 0
    v_mfma_f32_16x16x32_bf16 v[92:95], a[60:63], v[16:19], 0
    v_mfma_f32_16x16x32_bf16 v[88:91], a[28:31], v[16:19], 0
    ds_read_b128 v[28:31], v10 offset:3840
    ds_read_b128 a[240:243], v12 offset:3840
    ds_read_b128 a[208:211], v12 offset:3328
    ds_read_b128 a[176:179], v12 offset:2816
    ds_read_b128 a[144:147], v12 offset:2304
    ds_read_b128 a[112:115], v12 offset:1792
    ds_read_b128 a[80:83], v12 offset:1280
    ds_read_b128 a[48:51], v12 offset:768
    ds_read_b128 a[16:19], v12 offset:256
    v_mfma_f32_16x16x32_bf16 v[116:119], a[248:251], v[20:23], v[116:119]
    v_mfma_f32_16x16x32_bf16 v[112:115], a[216:219], v[20:23], v[112:115]
    s_waitcnt lgkmcnt(15)
    v_mfma_f32_16x16x32_bf16 v[108:111], a[184:187], v[20:23], v[108:111]
    v_mfma_f32_16x16x32_bf16 v[104:107], a[152:155], v[20:23], v[104:107]
    v_mfma_f32_16x16x32_bf16 v[100:103], a[120:123], v[20:23], v[100:103]
    v_mfma_f32_16x16x32_bf16 v[96:99], a[88:91], v[20:23], v[96:99]
    v_mfma_f32_16x16x32_bf16 v[92:95], a[56:59], v[20:23], v[92:95]
    v_mfma_f32_16x16x32_bf16 v[88:91], a[24:27], v[20:23], v[88:91]
    ds_read_b128 v[16:19], v10 offset:3776
    ds_read_b128 a[236:239], v12 offset:3776
    ds_read_b128 a[204:207], v12 offset:3264
    ds_read_b128 a[172:175], v12 offset:2752
    ds_read_b128 a[140:143], v12 offset:2240
    ds_read_b128 a[108:111], v12 offset:1728
    ds_read_b128 a[76:79], v12 offset:1216
    ds_read_b128 a[44:47], v12 offset:704
    ds_read_b128 a[12:15], v12 offset:192
    v_mfma_f32_16x16x32_bf16 v[116:119], a[244:247], v[24:27], v[116:119]
    v_mfma_f32_16x16x32_bf16 v[112:115], a[212:215], v[24:27], v[112:115]
    s_waitcnt lgkmcnt(15)
    v_mfma_f32_16x16x32_bf16 v[108:111], a[180:183], v[24:27], v[108:111]
    v_mfma_f32_16x16x32_bf16 v[104:107], a[148:151], v[24:27], v[104:107]
    v_mfma_f32_16x16x32_bf16 v[100:103], a[116:119], v[24:27], v[100:103]
    v_mfma_f32_16x16x32_bf16 v[96:99], a[84:87], v[24:27], v[96:99]
    v_mfma_f32_16x16x32_bf16 v[92:95], a[52:55], v[24:27], v[92:95]
    v_mfma_f32_16x16x32_bf16 v[88:91], a[20:23], v[24:27], v[88:91]
    ds_read_b128 v[20:23], v10 offset:3712
    ds_read_b128 a[232:235], v12 offset:3712
    ds_read_b128 a[200:203], v12 offset:3200
    ds_read_b128 a[168:171], v12 offset:2688
    ds_read_b128 a[136:139], v12 offset:2176
    ds_read_b128 a[104:107], v12 offset:1664
    ds_read_b128 a[72:75], v12 offset:1152
    ds_read_b128 a[40:43], v12 offset:640
    ds_read_b128 a[8:11], v12 offset:128
    v_mfma_f32_16x16x32_bf16 v[116:119], a[240:243], v[28:31], v[116:119]
    v_mfma_f32_16x16x32_bf16 v[112:115], a[208:211], v[28:31], v[112:115]
    s_waitcnt lgkmcnt(15)
    v_mfma_f32_16x16x32_bf16 v[108:111], a[176:179], v[28:31], v[108:111]
    v_mfma_f32_16x16x32_bf16 v[104:107], a[144:147], v[28:31], v[104:107]
    v_mfma_f32_16x16x32_bf16 v[100:103], a[112:115], v[28:31], v[100:103]
    v_mfma_f32_16x16x32_bf16 v[96:99], a[80:83], v[28:31], v[96:99]
    v_mfma_f32_16x16x32_bf16 v[92:95], a[48:51], v[28:31], v[92:95]
    v_mfma_f32_16x16x32_bf16 v[88:91], a[16:19], v[28:31], v[88:91]
    ds_read_b128 v[24:27], v10 offset:3648
    ds_read_b128 a[228:231], v12 offset:3648
    ds_read_b128 a[196:199], v12 offset:3136
    ds_read_b128 a[164:167], v12 offset:2624
    ds_read_b128 a[132:135], v12 offset:2112
    ds_read_b128 a[100:103], v12 offset:1600
    ds_read_b128 a[68:71], v12 offset:1088
    ds_read_b128 a[36:39], v12 offset:576
    ds_read_b128 a[4:7], v12 offset:64
    v_mfma_f32_16x16x32_bf16 v[116:119], a[236:239], v[16:19], v[116:119]
    v_mfma_f32_16x16x32_bf16 v[112:115], a[204:207], v[16:19], v[112:115]
    s_waitcnt lgkmcnt(15)
    v_mfma_f32_16x16x32_bf16 v[108:111], a[172:175], v[16:19], v[108:111]
    v_mfma_f32_16x16x32_bf16 v[104:107], a[140:143], v[16:19], v[104:107]
    v_mfma_f32_16x16x32_bf16 v[100:103], a[108:111], v[16:19], v[100:103]
    v_mfma_f32_16x16x32_bf16 v[96:99], a[76:79], v[16:19], v[96:99]
    v_mfma_f32_16x16x32_bf16 v[92:95], a[44:47], v[16:19], v[92:95]
    v_mfma_f32_16x16x32_bf16 v[88:91], a[12:15], v[16:19], v[88:91]
    ds_read_b128 v[28:31], v10 offset:3584
    ds_read_b128 a[224:227], v12 offset:3584
    ds_read_b128 a[192:195], v12 offset:3072
    ds_read_b128 a[160:163], v12 offset:2560
    ds_read_b128 a[128:131], v12 offset:2048
    ds_read_b128 a[96:99], v12 offset:1536
    ds_read_b128 a[64:67], v12 offset:1024
    ds_read_b128 a[32:35], v12 offset:512
    ds_read_b128 a[0:3], v12 offset:0
    v_mfma_f32_16x16x32_bf16 v[116:119], a[232:235], v[20:23], v[116:119]
    v_mfma_f32_16x16x32_bf16 v[112:115], a[200:203], v[20:23], v[112:115]
    s_waitcnt lgkmcnt(15)
    v_mfma_f32_16x16x32_bf16 v[108:111], a[168:171], v[20:23], v[108:111]
    v_mfma_f32_16x16x32_bf16 v[104:107], a[136:139], v[20:23], v[104:107]
    v_mfma_f32_16x16x32_bf16 v[100:103], a[104:107], v[20:23], v[100:103]
    v_mfma_f32_16x16x32_bf16 v[96:99], a[72:75], v[20:23], v[96:99]
    v_mfma_f32_16x16x32_bf16 v[92:95], a[40:43], v[20:23], v[92:95]
    v_mfma_f32_16x16x32_bf16 v[88:91], a[8:11], v[20:23], v[88:91]
    ds_read_b128 v[16:19], v10 offset:3520
    v_mfma_f32_16x16x32_bf16 v[116:119], a[228:231], v[24:27], v[116:119]
    v_mfma_f32_16x16x32_bf16 v[112:115], a[196:199], v[24:27], v[112:115]
    s_waitcnt lgkmcnt(15)
    v_mfma_f32_16x16x32_bf16 v[108:111], a[164:167], v[24:27], v[108:111]
    s_waitcnt lgkmcnt(14)
    v_mfma_f32_16x16x32_bf16 v[104:107], a[132:135], v[24:27], v[104:107]
    s_waitcnt lgkmcnt(13)
    v_mfma_f32_16x16x32_bf16 v[100:103], a[100:103], v[24:27], v[100:103]
    s_waitcnt lgkmcnt(12)
    v_mfma_f32_16x16x32_bf16 v[96:99], a[68:71], v[24:27], v[96:99]
    s_waitcnt lgkmcnt(11)
    v_mfma_f32_16x16x32_bf16 v[92:95], a[36:39], v[24:27], v[92:95]
    s_waitcnt lgkmcnt(10)
    v_mfma_f32_16x16x32_bf16 v[88:91], a[4:7], v[24:27], v[88:91]
    ds_read_b128 v[20:23], v10 offset:3456
    s_waitcnt lgkmcnt(9)
    v_mfma_f32_16x16x32_bf16 v[116:119], a[224:227], v[28:31], v[116:119]
    s_waitcnt lgkmcnt(8)
    v_mfma_f32_16x16x32_bf16 v[112:115], a[192:195], v[28:31], v[112:115]
    s_waitcnt lgkmcnt(7)
    v_mfma_f32_16x16x32_bf16 v[108:111], a[160:163], v[28:31], v[108:111]
    s_waitcnt lgkmcnt(6)
    v_mfma_f32_16x16x32_bf16 v[104:107], a[128:131], v[28:31], v[104:107]
    s_waitcnt lgkmcnt(5)
    v_mfma_f32_16x16x32_bf16 v[100:103], a[96:99], v[28:31], v[100:103]
    s_waitcnt lgkmcnt(4)
    v_mfma_f32_16x16x32_bf16 v[96:99], a[64:67], v[28:31], v[96:99]
    s_waitcnt lgkmcnt(3)
    v_mfma_f32_16x16x32_bf16 v[92:95], a[32:35], v[28:31], v[92:95]
    s_waitcnt lgkmcnt(2)
    v_mfma_f32_16x16x32_bf16 v[88:91], a[0:3], v[28:31], v[88:91]
    ds_read_b128 v[24:27], v10 offset:3392
    s_waitcnt lgkmcnt(2)
    v_mfma_f32_16x16x32_bf16 v[116:119], a[220:223], v[16:19], v[116:119]
    v_mfma_f32_16x16x32_bf16 v[112:115], a[188:191], v[16:19], v[112:115]
    v_mfma_f32_16x16x32_bf16 v[108:111], a[156:159], v[16:19], v[108:111]
    v_mfma_f32_16x16x32_bf16 v[104:107], a[124:127], v[16:19], v[104:107]
    v_mfma_f32_16x16x32_bf16 v[100:103], a[92:95], v[16:19], v[100:103]
    v_mfma_f32_16x16x32_bf16 v[96:99], a[60:63], v[16:19], v[96:99]
    v_mfma_f32_16x16x32_bf16 v[92:95], a[28:31], v[16:19], v[92:95]
    ds_read_b128 v[28:31], v10 offset:3328
    s_waitcnt lgkmcnt(2)
    v_mfma_f32_16x16x32_bf16 v[116:119], a[216:219], v[20:23], v[116:119]
    v_mfma_f32_16x16x32_bf16 v[112:115], a[184:187], v[20:23], v[112:115]
    v_mfma_f32_16x16x32_bf16 v[108:111], a[152:155], v[20:23], v[108:111]
    v_mfma_f32_16x16x32_bf16 v[104:107], a[120:123], v[20:23], v[104:107]
    v_mfma_f32_16x16x32_bf16 v[100:103], a[88:91], v[20:23], v[100:103]
    v_mfma_f32_16x16x32_bf16 v[96:99], a[56:59], v[20:23], v[96:99]
    v_mfma_f32_16x16x32_bf16 v[92:95], a[24:27], v[20:23], v[92:95]
    ds_read_b128 v[16:19], v10 offset:3264
    s_waitcnt lgkmcnt(2)
    v_mfma_f32_16x16x32_bf16 v[116:119], a[212:215], v[24:27], v[116:119]
    v_mfma_f32_16x16x32_bf16 v[112:115], a[180:183], v[24:27], v[112:115]
    v_mfma_f32_16x16x32_bf16 v[108:111], a[148:151], v[24:27], v[108:111]
    v_mfma_f32_16x16x32_bf16 v[104:107], a[116:119], v[24:27], v[104:107]
    v_mfma_f32_16x16x32_bf16 v[100:103], a[84:87], v[24:27], v[100:103]
    v_mfma_f32_16x16x32_bf16 v[96:99], a[52:55], v[24:27], v[96:99]
    v_mfma_f32_16x16x32_bf16 v[92:95], a[20:23], v[24:27], v[92:95]
    ds_read_b128 v[20:23], v10 offset:3200
    s_waitcnt lgkmcnt(2)
    v_mfma_f32_16x16x32_bf16 v[116:119], a[208:211], v[28:31], v[116:119]
    v_mfma_f32_16x16x32_bf16 v[112:115], a[176:179], v[28:31], v[112:115]
    v_mfma_f32_16x16x32_bf16 v[108:111], a[144:147], v[28:31], v[108:111]
    v_mfma_f32_16x16x32_bf16 v[104:107], a[112:115], v[28:31], v[104:107]
    v_mfma_f32_16x16x32_bf16 v[100:103], a[80:83], v[28:31], v[100:103]
    v_mfma_f32_16x16x32_bf16 v[96:99], a[48:51], v[28:31], v[96:99]
    v_mfma_f32_16x16x32_bf16 v[92:95], a[16:19], v[28:31], v[92:95]
    ds_read_b128 v[24:27], v10 offset:3136
    s_waitcnt lgkmcnt(2)
    v_mfma_f32_16x16x32_bf16 v[116:119], a[204:207], v[16:19], v[116:119]
    v_mfma_f32_16x16x32_bf16 v[112:115], a[172:175], v[16:19], v[112:115]
    v_mfma_f32_16x16x32_bf16 v[108:111], a[140:143], v[16:19], v[108:111]
    v_mfma_f32_16x16x32_bf16 v[104:107], a[108:111], v[16:19], v[104:107]
    v_mfma_f32_16x16x32_bf16 v[100:103], a[76:79], v[16:19], v[100:103]
    v_mfma_f32_16x16x32_bf16 v[96:99], a[44:47], v[16:19], v[96:99]
    v_mfma_f32_16x16x32_bf16 v[92:95], a[12:15], v[16:19], v[92:95]
    ds_read_b128 v[28:31], v10 offset:3072
    s_waitcnt lgkmcnt(2)
    v_mfma_f32_16x16x32_bf16 v[116:119], a[200:203], v[20:23], v[116:119]
    v_mfma_f32_16x16x32_bf16 v[112:115], a[168:171], v[20:23], v[112:115]
    v_mfma_f32_16x16x32_bf16 v[108:111], a[136:139], v[20:23], v[108:111]
    v_mfma_f32_16x16x32_bf16 v[104:107], a[104:107], v[20:23], v[104:107]
    v_mfma_f32_16x16x32_bf16 v[100:103], a[72:75], v[20:23], v[100:103]
    v_mfma_f32_16x16x32_bf16 v[96:99], a[40:43], v[20:23], v[96:99]
    v_mfma_f32_16x16x32_bf16 v[92:95], a[8:11], v[20:23], v[92:95]
    ds_read_b128 v[16:19], v10 offset:3008
    s_waitcnt lgkmcnt(2)
    v_mfma_f32_16x16x32_bf16 v[116:119], a[196:199], v[24:27], v[116:119]
    v_mfma_f32_16x16x32_bf16 v[112:115], a[164:167], v[24:27], v[112:115]
    v_mfma_f32_16x16x32_bf16 v[108:111], a[132:135], v[24:27], v[108:111]
    v_mfma_f32_16x16x32_bf16 v[104:107], a[100:103], v[24:27], v[104:107]
    v_mfma_f32_16x16x32_bf16 v[100:103], a[68:71], v[24:27], v[100:103]
    v_mfma_f32_16x16x32_bf16 v[96:99], a[36:39], v[24:27], v[96:99]
    v_mfma_f32_16x16x32_bf16 v[92:95], a[4:7], v[24:27], v[92:95]
    ds_read_b128 v[20:23], v10 offset:2944
    s_waitcnt lgkmcnt(2)
    v_mfma_f32_16x16x32_bf16 v[116:119], a[192:195], v[28:31], v[116:119]
    v_mfma_f32_16x16x32_bf16 v[112:115], a[160:163], v[28:31], v[112:115]
    v_mfma_f32_16x16x32_bf16 v[108:111], a[128:131], v[28:31], v[108:111]
    v_mfma_f32_16x16x32_bf16 v[104:107], a[96:99], v[28:31], v[104:107]
    v_mfma_f32_16x16x32_bf16 v[100:103], a[64:67], v[28:31], v[100:103]
    v_mfma_f32_16x16x32_bf16 v[96:99], a[32:35], v[28:31], v[96:99]
    v_mfma_f32_16x16x32_bf16 v[92:95], a[0:3], v[28:31], v[92:95]
    ds_read_b128 v[24:27], v10 offset:2880
    s_waitcnt lgkmcnt(2)
    v_mfma_f32_16x16x32_bf16 v[116:119], a[188:191], v[16:19], v[116:119]
    v_mfma_f32_16x16x32_bf16 v[112:115], a[156:159], v[16:19], v[112:115]
    v_mfma_f32_16x16x32_bf16 v[108:111], a[124:127], v[16:19], v[108:111]
    v_mfma_f32_16x16x32_bf16 v[104:107], a[92:95], v[16:19], v[104:107]
    v_mfma_f32_16x16x32_bf16 v[100:103], a[60:63], v[16:19], v[100:103]
    v_mfma_f32_16x16x32_bf16 v[96:99], a[28:31], v[16:19], v[96:99]
    s_waitcnt lgkmcnt(1)
    v_mfma_f32_16x16x32_bf16 v[116:119], a[184:187], v[20:23], v[116:119]
    v_mfma_f32_16x16x32_bf16 v[112:115], a[152:155], v[20:23], v[112:115]
    v_mfma_f32_16x16x32_bf16 v[108:111], a[120:123], v[20:23], v[108:111]
    v_mfma_f32_16x16x32_bf16 v[104:107], a[88:91], v[20:23], v[104:107]
    v_mfma_f32_16x16x32_bf16 v[100:103], a[56:59], v[20:23], v[100:103]
    v_mfma_f32_16x16x32_bf16 v[96:99], a[24:27], v[20:23], v[96:99]
    s_waitcnt lgkmcnt(0)
    v_mfma_f32_16x16x32_bf16 v[116:119], a[180:183], v[24:27], v[116:119]
    v_mfma_f32_16x16x32_bf16 v[112:115], a[148:151], v[24:27], v[112:115]
    v_mfma_f32_16x16x32_bf16 v[108:111], a[116:119], v[24:27], v[108:111]
    v_mfma_f32_16x16x32_bf16 v[104:107], a[84:87], v[24:27], v[104:107]
    v_mfma_f32_16x16x32_bf16 v[100:103], a[52:55], v[24:27], v[100:103]
    v_mfma_f32_16x16x32_bf16 v[96:99], a[20:23], v[24:27], v[96:99]
    v_mfma_f32_16x16x32_bf16 v[88:91], a[28:31], v[32:35], v[88:91]
    v_mfma_f32_16x16x32_bf16 v[92:95], a[60:63], v[32:35], v[92:95]
    v_mfma_f32_16x16x32_bf16 v[96:99], a[92:95], v[32:35], v[96:99]
    v_mfma_f32_16x16x32_bf16 v[100:103], a[124:127], v[32:35], v[100:103]
    v_mfma_f32_16x16x32_bf16 v[104:107], a[156:159], v[32:35], v[104:107]
    v_mfma_f32_16x16x32_bf16 v[108:111], a[188:191], v[32:35], v[108:111]
    v_mfma_f32_16x16x32_bf16 v[112:115], a[220:223], v[32:35], v[112:115]
    v_mfma_f32_16x16x32_bf16 v[116:119], a[252:255], v[32:35], v[116:119]
    s_branch L_kf_join
L_kf_w1:
    v_mov_b32 v88, 0
    v_mov_b32 v89, 0
    v_mov_b32 v90, 0
    v_mov_b32 v91, 0
    v_mov_b32 v92, 0
    v_mov_b32 v93, 0
    v_mov_b32 v94, 0
    v_mov_b32 v95, 0
    ds_read_b128 v[28:31], v10 offset:2816
    ds_read_b128 a[176:179], v12 offset:2816
    ds_read_b128 a[144:147], v12 offset:2304
    ds_read_b128 a[112:115], v12 offset:1792
    ds_read_b128 a[80:83], v12 offset:1280
    ds_read_b128 a[48:51], v12 offset:768
    ds_read_b128 a[16:19], v12 offset:256
    ds_read_b128 v[16:19], v10 offset:2752
    ds_read_b128 a[172:175], v12 offset:2752
    ds_read_b128 a[140:143], v12 offset:2240
    ds_read_b128 a[108:111], v12 offset:1728
    ds_read_b128 a[76:79], v12 offset:1216
    ds_read_b128 a[44:47], v12 offset:704
    ds_read_b128 a[12:15], v12 offset:192
    ds_read_b128 v[20:23], v10 offset:2688
    ds_read_b128 a[168:171], v12 offset:2688
    ds_read_b128 a[136:139], v12 offset:2176
    ds_read_b128 a[104:107], v12 offset:1664
    ds_read_b128 a[72:75], v12 offset:1152
    ds_read_b128 a[40:43], v12 offset:640
    ds_read_b128 a[8:11], v12 offset:128
    s_waitcnt lgkmcnt(15)
    v_mfma_f32_16x16x32_bf16 v[116:119], a[176:179], v[28:31], 0
    v_mfma_f32_16x16x32_bf16 v[112:115], a[144:147], v[28:31], 0
    v_mfma_f32_16x16x32_bf16 v[108:111], a[112:115], v[28:31], 0
    v_mfma_f32_16x16x32_bf16 v[104:107], a[80:83], v[28:31], 0
    v_mfma_f32_16x16x32_bf16 v[100:103], a[48:51], v[28:31], 0
    s_waitcnt lgkmcnt(14)
    v_mfma_f32_16x16x32_bf16 v[96:99], a[16:19], v[28:31], 0
    ds_read_b128 v[24:27], v10 offset:2624
    ds_read_b128 a[164:167], v12 offset:2624
    ds_read_b128 a[132:135], v12 offset:2112
    ds_read_b128 a[100:103], v12 offset:1600
    ds_read_b128 a[68:71], v12 offset:1088
    ds_read_b128 a[36:39], v12 offset:576
    ds_read_b128 a[4:7], v12 offset:64
    s_waitcnt lgkmcnt(15)
    v_mfma_f32_16x16x32_bf16 v[116:119], a[172:175], v[16:19], v[116:119]
    v_mfma_f32_16x16x32_bf16 v[112:115], a[140:143], v[16:19], v[112:115]
    v_mfma_f32_16x16x32_bf16 v[108:111], a[108:111], v[16:19], v[108:111]
    v_mfma_f32_16x16x32_bf16 v[104:107], a[76:79], v[16:19], v[104:107]
    v_mfma_f32_16x16x32_bf16 v[100:103], a[44:47], v[16:19], v[100:103]
    s_waitcnt lgkmcnt(14)
    v_mfma_f32_16x16x32_bf16 v[96:99], a[12:15], v[16:19], v[96:99]
    ds_read_b128 v[28:31], v10 offset:2560
    ds_read_b128 a[160:163], v12 offset:2560
    ds_read_b128 a[128:131], v12 offset:2048
    ds_read_b128 a[96:99], v12 offset:1536
    ds_read_b128 a[64:67], v12 offset:1024
    ds_read_b128 a[32:35], v12 offset:512
    ds_read_b128 a[0:3], v12 offset:0
    s_waitcnt lgkmcnt(15)
    v_mfma_f32_16x16x32_bf16 v[116:119], a[168:171], v[20:23], v[116:119]
    v_mfma_f32_16x16x32_bf16 v[112:115], a[136:139], v[20:23], v[112:115]
    v_mfma_f32_16x16x32_bf16 v[108:111], a[104:107], v[20:23], v[108:111]
    v_mfma_f32_16x16x32_bf16 v[104:107], a[72:75], v[20:23], v[104:107]
    v_mfma_f32_16x16x32_bf16 v[100:103], a[40:43], v[20:23], v[100:103]
    s_waitcnt lgkmcnt(14)
    v_mfma_f32_16x16x32_bf16 v[96:99], a[8:11], v[20:23], v[96:99]
    ds_read_b128 v[16:19], v10 offset:2496
    ds_read_b128 a[156:159], v12 offset:2496
    ds_read_b128 a[124:127], v12 offset:1984
    ds_read_b128 a[92:95], v12 offset:1472
    ds_read_b128 a[60:63], v12 offset:960
    ds_read_b128 a[28:31], v12 offset:448
    s_waitcnt lgkmcnt(15)
    v_mfma_f32_16x16x32_bf16 v[116:119], a[164:167], v[24:27], v[116:119]
    v_mfma_f32_16x16x32_bf16 v[112:115], a[132:135], v[24:27], v[112:115]
    v_mfma_f32_16x16x32_bf16 v[108:111], a[100:103], v[24:27], v[108:111]
    v_mfma_f32_16x16x32_bf16 v[104:107], a[68:71], v[24:27], v[104:107]
    s_waitcnt lgkmcnt(14)
    v_mfma_f32_16x16x32_bf16 v[100:103], a[36:39], v[24:27], v[100:103]
    s_waitcnt lgkmcnt(13)
    v_mfma_f32_16x16x32_bf16 v[96:99], a[4:7], v[24:27], v[96:99]
    ds_read_b128 v[20:23], v10 offset:2432
    ds_read_b128 a[152:155], v12 offset:2432
    ds_read_b128 a[120:123], v12 offset:1920
    ds_read_b128 a[88:91], v12 offset:1408
    ds_read_b128 a[56:59], v12 offset:896
    ds_read_b128 a[24:27], v12 offset:384
    s_waitcnt lgkmcnt(15)
    v_mfma_f32_16x16x32_bf16 v[116:119], a[160:163], v[28:31], v[116:119]
    v_mfma_f32_16x16x32_bf16 v[112:115], a[128:131], v[28:31], v[112:115]
    v_mfma_f32_16x16x32_bf16 v[108:111], a[96:99], v[28:31], v[108:111]
    s_waitcnt lgkmcnt(14)
    v_mfma_f32_16x16x32_bf16 v[104:107], a[64:67], v[28:31], v[104:107]
    s_waitcnt lgkmcnt(13)
    v_mfma_f32_16x16x32_bf16 v[100:103], a[32:35], v[28:31], v[100:103]
    s_waitcnt lgkmcnt(12)
    v_mfma_f32_16x16x32_bf16 v[96:99], a[0:3], v[28:31], v[96:99]
    ds_read_b128 v[24:27], v10 offset:2368
    ds_read_b128 a[148:151], v12 offset:2368
    ds_read_b128 a[116:119], v12 offset:1856
    ds_read_b128 a[84:87], v12 offset:1344
    ds_read_b128 a[52:55], v12 offset:832
    ds_read_b128 a[20:23], v12 offset:320
    s_waitcnt lgkmcnt(15)
    v_mfma_f32_16x16x32_bf16 v[116:119], a[156:159], v[16:19], v[116:119]
    v_mfma_f32_16x16x32_bf16 v[112:115], a[124:127], v[16:19], v[112:115]
    s_waitcnt lgkmcnt(14)
    v_mfma_f32_16x16x32_bf16 v[108:111], a[92:95], v[16:19], v[108:111]
    s_waitcnt lgkmcnt(13)
    v_mfma_f32_16x16x32_bf16 v[104:107], a[60:63], v[16:19], v[104:107]
    s_waitcnt lgkmcnt(12)
    v_mfma_f32_16x16x32_bf16 v[100:103], a[28:31], v[16:19], v[100:103]
    ds_read_b128 v[28:31], v10 offset:2304
    s_waitcnt lgkmcnt(11)
    v_mfma_f32_16x16x32_bf16 v[116:119], a[152:155], v[20:23], v[116:119]
    s_waitcnt lgkmcnt(10)
    v_mfma_f32_16x16x32_bf16 v[112:115], a[120:123], v[20:23], v[112:115]
    s_waitcnt lgkmcnt(9)
    v_mfma_f32_16x16x32_bf16 v[108:111], a[88:91], v[20:23], v[108:111]
    s_waitcnt lgkmcnt(8)
    v_mfma_f32_16x16x32_bf16 v[104:107], a[56:59], v[20:23], v[104:107]
    s_waitcnt lgkmcnt(7)
    v_mfma_f32_16x16x32_bf16 v[100:103], a[24:27], v[20:23], v[100:103]
    ds_read_b128 v[16:19], v10 offset:2240
    s_waitcnt lgkmcnt(6)
    v_mfma_f32_16x16x32_bf16 v[116:119], a[148:151], v[24:27], v[116:119]
    s_waitcnt lgkmcnt(5)
    v_mfma_f32_16x16x32_bf16 v[112:115], a[116:119], v[24:27], v[112:115]
    s_waitcnt lgkmcnt(4)
    v_mfma_f32_16x16x32_bf16 v[108:111], a[84:87], v[24:27], v[108:111]
    s_waitcnt lgkmcnt(3)
    v_mfma_f32_16x16x32_bf16 v[104:107], a[52:55], v[24:27], v[104:107]
    s_waitcnt lgkmcnt(2)
    v_mfma_f32_16x16x32_bf16 v[100:103], a[20:23], v[24:27], v[100:103]
    ds_read_b128 v[20:23], v10 offset:2176
    s_waitcnt lgkmcnt(2)
    v_mfma_f32_16x16x32_bf16 v[116:119], a[144:147], v[28:31], v[116:119]
    v_mfma_f32_16x16x32_bf16 v[112:115], a[112:115], v[28:31], v[112:115]
    v_mfma_f32_16x16x32_bf16 v[108:111], a[80:83], v[28:31], v[108:111]
    v_mfma_f32_16x16x32_bf16 v[104:107], a[48:51], v[28:31], v[104:107]
    v_mfma_f32_16x16x32_bf16 v[100:103], a[16:19], v[28:31], v[100:103]
    ds_read_b128 v[24:27], v10 offset:2112
    s_waitcnt lgkmcnt(2)
    v_mfma_f32_16x16x32_bf16 v[116:119], a[140:143], v[16:19], v[116:119]
    v_mfma_f32_16x16x32_bf16 v[112:115], a[108:111], v[16:19], v[112:115]
    v_mfma_f32_16x16x32_bf16 v[108:111], a[76:79], v[16:19], v[108:111]
    v_mfma_f32_16x16x32_bf16 v[104:107], a[44:47], v[16:19], v[104:107]
    v_mfma_f32_16x16x32_bf16 v[100:103], a[12:15], v[16:19], v[100:103]
    ds_read_b128 v[28:31], v10 offset:2048
    s_waitcnt lgkmcnt(2)
    v_mfma_f32_16x16x32_bf16 v[116:119], a[136:139], v[20:23], v[116:119]
    v_mfma_f32_16x16x32_bf16 v[112:115], a[104:107], v[20:23], v[112:115]
    v_mfma_f32_16x16x32_bf16 v[108:111], a[72:75], v[20:23], v[108:111]
    v_mfma_f32_16x16x32_bf16 v[104:107], a[40:43], v[20:23], v[104:107]
    v_mfma_f32_16x16x32_bf16 v[100:103], a[8:11], v[20:23], v[100:103]
    ds_read_b128 v[16:19], v10 offset:1984
    s_waitcnt lgkmcnt(2)
    v_mfma_f32_16x16x32_bf16 v[116:119], a[132:135], v[24:27], v[116:119]
    v_mfma_f32_16x16x32_bf16 v[112:115], a[100:103], v[24:27], v[112:115]
    v_mfma_f32_16x16x32_bf16 v[108:111], a[68:71], v[24:27], v[108:111]
    v_mfma_f32_16x16x32_bf16 v[104:107], a[36:39], v[24:27], v[104:107]
    v_mfma_f32_16x16x32_bf16 v[100:103], a[4:7], v[24:27], v[100:103]
    ds_read_b128 v[20:23], v10 offset:1920
    s_waitcnt lgkmcnt(2)
    v_mfma_f32_16x16x32_bf16 v[116:119], a[128:131], v[28:31], v[116:119]
    v_mfma_f32_16x16x32_bf16 v[112:115], a[96:99], v[28:31], v[112:115]
    v_mfma_f32_16x16x32_bf16 v[108:111], a[64:67], v[28:31], v[108:111]
    v_mfma_f32_16x16x32_bf16 v[104:107], a[32:35], v[28:31], v[104:107]
    v_mfma_f32_16x16x32_bf16 v[100:103], a[0:3], v[28:31], v[100:103]
    ds_read_b128 v[24:27], v10 offset:1856
    s_waitcnt lgkmcnt(2)
    v_mfma_f32_16x16x32_bf16 v[116:119], a[124:127], v[16:19], v[116:119]
    v_mfma_f32_16x16x32_bf16 v[112:115], a[92:95], v[16:19], v[112:115]
    v_mfma_f32_16x16x32_bf16 v[108:111], a[60:63], v[16:19], v[108:111]
    v_mfma_f32_16x16x32_bf16 v[104:107], a[28:31], v[16:19], v[104:107]
    ds_read_b128 v[28:31], v10 offset:1792
    s_waitcnt lgkmcnt(2)
    v_mfma_f32_16x16x32_bf16 v[116:119], a[120:123], v[20:23], v[116:119]
    v_mfma_f32_16x16x32_bf16 v[112:115], a[88:91], v[20:23], v[112:115]
    v_mfma_f32_16x16x32_bf16 v[108:111], a[56:59], v[20:23], v[108:111]
    v_mfma_f32_16x16x32_bf16 v[104:107], a[24:27], v[20:23], v[104:107]
    ds_read_b128 v[16:19], v10 offset:1728
    s_waitcnt lgkmcnt(2)
    v_mfma_f32_16x16x32_bf16 v[116:119], a[116:119], v[24:27], v[116:119]
    v_mfma_f32_16x16x32_bf16 v[112:115], a[84:87], v[24:27], v[112:115]
    v_mfma_f32_16x16x32_bf16 v[108:111], a[52:55], v[24:27], v[108:111]
    v_mfma_f32_16x16x32_bf16 v[104:107], a[20:23], v[24:27], v[104:107]
    ds_read_b128 v[20:23], v10 offset:1664
    s_waitcnt lgkmcnt(2)
    v_mfma_f32_16x16x32_bf16 v[116:119], a[112:115], v[28:31], v[116:119]
    v_mfma_f32_16x16x32_bf16 v[112:115], a[80:83], v[28:31], v[112:115]
    v_mfma_f32_16x16x32_bf16 v[108:111], a[48:51], v[28:31], v[108:111]
    v_mfma_f32_16x16x32_bf16 v[104:107], a[16:19], v[28:31], v[104:107]
    ds_read_b128 v[24:27], v10 offset:1600
    s_waitcnt lgkmcnt(2)
    v_mfma_f32_16x16x32_bf16 v[116:119], a[108:111], v[16:19], v[116:119]
    v_mfma_f32_16x16x32_bf16 v[112:115], a[76:79], v[16:19], v[112:115]
    v_mfma_f32_16x16x32_bf16 v[108:111], a[44:47], v[16:19], v[108:111]
    v_mfma_f32_16x16x32_bf16 v[104:107], a[12:15], v[16:19], v[104:107]
    ds_read_b128 v[28:31], v10 offset:1536
    s_waitcnt lgkmcnt(2)
    v_mfma_f32_16x16x32_bf16 v[116:119], a[104:107], v[20:23], v[116:119]
    v_mfma_f32_16x16x32_bf16 v[112:115], a[72:75], v[20:23], v[112:115]
    v_mfma_f32_16x16x32_bf16 v[108:111], a[40:43], v[20:23], v[108:111]
    v_mfma_f32_16x16x32_bf16 v[104:107], a[8:11], v[20:23], v[104:107]
    ds_read_b128 v[16:19], v10 offset:1472
    s_waitcnt lgkmcnt(2)
    v_mfma_f32_16x16x32_bf16 v[116:119], a[100:103], v[24:27], v[116:119]
    v_mfma_f32_16x16x32_bf16 v[112:115], a[68:71], v[24:27], v[112:115]
    v_mfma_f32_16x16x32_bf16 v[108:111], a[36:39], v[24:27], v[108:111]
    v_mfma_f32_16x16x32_bf16 v[104:107], a[4:7], v[24:27], v[104:107]
    ds_read_b128 v[20:23], v10 offset:1408
    s_waitcnt lgkmcnt(2)
    v_mfma_f32_16x16x32_bf16 v[116:119], a[96:99], v[28:31], v[116:119]
    v_mfma_f32_16x16x32_bf16 v[112:115], a[64:67], v[28:31], v[112:115]
    v_mfma_f32_16x16x32_bf16 v[108:111], a[32:35], v[28:31], v[108:111]
    v_mfma_f32_16x16x32_bf16 v[104:107], a[0:3], v[28:31], v[104:107]
    ds_read_b128 v[24:27], v10 offset:1344
    s_waitcnt lgkmcnt(2)
    v_mfma_f32_16x16x32_bf16 v[116:119], a[92:95], v[16:19], v[116:119]
    v_mfma_f32_16x16x32_bf16 v[112:115], a[60:63], v[16:19], v[112:115]
    v_mfma_f32_16x16x32_bf16 v[108:111], a[28:31], v[16:19], v[108:111]
    ds_read_b128 v[28:31], v10 offset:1280
    s_waitcnt lgkmcnt(2)
    v_mfma_f32_16x16x32_bf16 v[116:119], a[88:91], v[20:23], v[116:119]
    v_mfma_f32_16x16x32_bf16 v[112:115], a[56:59], v[20:23], v[112:115]
    v_mfma_f32_16x16x32_bf16 v[108:111], a[24:27], v[20:23], v[108:111]
    ds_read_b128 v[16:19], v10 offset:1216
    s_waitcnt lgkmcnt(2)
    v_mfma_f32_16x16x32_bf16 v[116:119], a[84:87], v[24:27], v[116:119]
    v_mfma_f32_16x16x32_bf16 v[112:115], a[52:55], v[24:27], v[112:115]
    v_mfma_f32_16x16x32_bf16 v[108:111], a[20:23], v[24:27], v[108:111]
    ds_read_b128 v[20:23], v10 offset:1152
    s_waitcnt lgkmcnt(2)
    v_mfma_f32_16x16x32_bf16 v[116:119], a[80:83], v[28:31], v[116:119]
    v_mfma_f32_16x16x32_bf16 v[112:115], a[48:51], v[28:31], v[112:115]
    v_mfma_f32_16x16x32_bf16 v[108:111], a[16:19], v[28:31], v[108:111]
    ds_read_b128 v[24:27], v10 offset:1088
    s_waitcnt lgkmcnt(2)
    v_mfma_f32_16x16x32_bf16 v[116:119], a[76:79], v[16:19], v[116:119]
    v_mfma_f32_16x16x32_bf16 v[112:115], a[44:47], v[16:19], v[112:115]
    v_mfma_f32_16x16x32_bf16 v[108:111], a[12:15], v[16:19], v[108:111]
    ds_read_b128 v[28:31], v10 offset:1024
    s_waitcnt lgkmcnt(2)
    v_mfma_f32_16x16x32_bf16 v[116:119], a[72:75], v[20:23], v[116:119]
    v_mfma_f32_16x16x32_bf16 v[112:115], a[40:43], v[20:23], v[112:115]
    v_mfma_f32_16x16x32_bf16 v[108:111], a[8:11], v[20:23], v[108:111]
    ds_read_b128 v[16:19], v10 offset:960
    s_waitcnt lgkmcnt(2)
    v_mfma_f32_16x16x32_bf16 v[116:119], a[68:71], v[24:27], v[116:119]
    v_mfma_f32_16x16x32_bf16 v[112:115], a[36:39], v[24:27], v[112:115]
    v_mfma_f32_16x16x32_bf16 v[108:111], a[4:7], v[24:27], v[108:111]
    ds_read_b128 v[20:23], v10 offset:896
    s_waitcnt lgkmcnt(2)
    v_mfma_f32_16x16x32_bf16 v[116:119], a[64:67], v[28:31], v[116:119]
    v_mfma_f32_16x16x32_bf16 v[112:115], a[32:35], v[28:31], v[112:115]
    v_mfma_f32_16x16x32_bf16 v[108:111], a[0:3], v[28:31], v[108:111]
    ds_read_b128 v[24:27], v10 offset:832
    s_waitcnt lgkmcnt(2)
    v_mfma_f32_16x16x32_bf16 v[116:119], a[60:63], v[16:19], v[116:119]
    v_mfma_f32_16x16x32_bf16 v[112:115], a[28:31], v[16:19], v[112:115]
    ds_read_b128 v[28:31], v10 offset:768
    s_waitcnt lgkmcnt(2)
    v_mfma_f32_16x16x32_bf16 v[116:119], a[56:59], v[20:23], v[116:119]
    v_mfma_f32_16x16x32_bf16 v[112:115], a[24:27], v[20:23], v[112:115]
    ds_read_b128 v[16:19], v10 offset:704
    s_waitcnt lgkmcnt(2)
    v_mfma_f32_16x16x32_bf16 v[116:119], a[52:55], v[24:27], v[116:119]
    v_mfma_f32_16x16x32_bf16 v[112:115], a[20:23], v[24:27], v[112:115]
    ds_read_b128 v[20:23], v10 offset:640
    s_waitcnt lgkmcnt(2)
    v_mfma_f32_16x16x32_bf16 v[116:119], a[48:51], v[28:31], v[116:119]
    v_mfma_f32_16x16x32_bf16 v[112:115], a[16:19], v[28:31], v[112:115]
    ds_read_b128 v[24:27], v10 offset:576
    s_waitcnt lgkmcnt(2)
    v_mfma_f32_16x16x32_bf16 v[116:119], a[44:47], v[16:19], v[116:119]
    v_mfma_f32_16x16x32_bf16 v[112:115], a[12:15], v[16:19], v[112:115]
    ds_read_b128 v[28:31], v10 offset:512
    s_waitcnt lgkmcnt(2)
    v_mfma_f32_16x16x32_bf16 v[116:119], a[40:43], v[20:23], v[116:119]
    v_mfma_f32_16x16x32_bf16 v[112:115], a[8:11], v[20:23], v[112:115]
    ds_read_b128 v[16:19], v10 offset:448
    s_waitcnt lgkmcnt(2)
    v_mfma_f32_16x16x32_bf16 v[116:119], a[36:39], v[24:27], v[116:119]
    v_mfma_f32_16x16x32_bf16 v[112:115], a[4:7], v[24:27], v[112:115]
    ds_read_b128 v[20:23], v10 offset:384
    s_waitcnt lgkmcnt(2)
    v_mfma_f32_16x16x32_bf16 v[116:119], a[32:35], v[28:31], v[116:119]
    v_mfma_f32_16x16x32_bf16 v[112:115], a[0:3], v[28:31], v[112:115]
    ds_read_b128 v[24:27], v10 offset:320
    s_waitcnt lgkmcnt(2)
    v_mfma_f32_16x16x32_bf16 v[116:119], a[28:31], v[16:19], v[116:119]
    ds_read_b128 v[28:31], v10 offset:256
    s_waitcnt lgkmcnt(2)
    v_mfma_f32_16x16x32_bf16 v[116:119], a[24:27], v[20:23], v[116:119]
    ds_read_b128 v[16:19], v10 offset:192
    s_waitcnt lgkmcnt(2)
    v_mfma_f32_16x16x32_bf16 v[116:119], a[20:23], v[24:27], v[116:119]
    ds_read_b128 v[20:23], v10 offset:128
    s_waitcnt lgkmcnt(2)
    v_mfma_f32_16x16x32_bf16 v[116:119], a[16:19], v[28:31], v[116:119]
    ds_read_b128 v[24:27], v10 offset:64
    s_waitcnt lgkmcnt(2)
    v_mfma_f32_16x16x32_bf16 v[116:119], a[12:15], v[16:19], v[116:119]
    ds_read_b128 v[28:31], v10 offset:0
    s_waitcnt lgkmcnt(2)
    v_mfma_f32_16x16x32_bf16 v[116:119], a[8:11], v[20:23], v[116:119]
    s_waitcnt lgkmcnt(1)
    v_mfma_f32_16x16x32_bf16 v[116:119], a[4:7], v[24:27], v[116:119]
    s_waitcnt lgkmcnt(0)
    v_mfma_f32_16x16x32_bf16 v[116:119], a[0:3], v[28:31], v[116:119]
L_kf_join:
    s_nop 7
    ds_write_b128 v13, v[88:91] offset:0
    ds_write_b128 v13, v[92:95] offset:1024
    ds_write_b128 v13, v[96:99] offset:2048
    ds_write_b128 v13, v[100:103] offset:3072
    ds_write_b128 v13, v[104:107] offset:4096
    ds_write_b128 v13, v[108:111] offset:5120
    ds_write_b128 v13, v[112:115] offset:6144
    ds_write_b128 v13, v[116:119] offset:7168
    s_mov_b32 s4, 0xffff0000
    s_mov_b32 s3, 0
L_kf_sv:
    s_waitcnt vmcnt(0)
    v_xor_b32 v40, s54, v126
    v_xor_b32 v41, s54, v130
    v_or_b32 v40, v40, v41
    v_xor_b32 v41, s54, v134
    v_or_b32 v40, v40, v41
    v_xor_b32 v41, s54, v138
    v_or_b32 v40, v40, v41
    v_xor_b32 v41, s54, v142
    v_or_b32 v40, v40, v41
    v_xor_b32 v41, s54, v146
    v_or_b32 v40, v40, v41
    v_xor_b32 v41, s54, v150
    v_or_b32 v40, v40, v41
    v_xor_b32 v41, s54, v154
    v_or_b32 v40, v40, v41
    v_cmp_ne_u32 vcc, 0, v40
    s_add_u32 s3, s3, 1
    s_cmp_gt_u32 s3, 0x40000
    s_cbranch_scc1 L_kf_svd
    s_cbranch_vccz L_kf_svd
    buffer_load_dwordx4 v[124:127], v67, s[40:43], s9 offen offset:0 sc1
    buffer_load_dwordx4 v[128:131], v67, s[40:43], s9 offen offset:256 sc1
    buffer_load_dwordx4 v[132:135], v67, s[40:43], s9 offen offset:512 sc1
    buffer_load_dwordx4 v[136:139], v67, s[40:43], s9 offen offset:768 sc1
    buffer_load_dwordx4 v[140:143], v67, s[40:43], s10 offen offset:0 sc1
    buffer_load_dwordx4 v[144:147], v67, s[40:43], s10 offen offset:256 sc1
    buffer_load_dwordx4 v[148:151], v67, s[40:43], s10 offen offset:512 sc1
    buffer_load_dwordx4 v[152:155], v67, s[40:43], s10 offen offset:768 sc1
    s_branch L_kf_sv
L_kf_svd:
    s_waitcnt lgkmcnt(0)
    s_barrier
    ds_read_b128 v[88:91], v14 offset:0
    ds_read_b128 v[92:95], v14 offset:8192
    ds_read_b128 v[96:99], v14 offset:16384
    ds_read_b128 v[100:103], v14 offset:24576
    ds_read_b128 v[104:107], v14 offset:1024
    ds_read_b128 v[108:111], v14 offset:9216
    ds_read_b128 v[112:115], v14 offset:17408
    ds_read_b128 v[116:119], v14 offset:25600
    s_waitcnt lgkmcnt(4)
    v_add_f32 v88, v88, v92
    v_add_f32 v96, v96, v100
    v_lshlrev_b32 v24, 16, v68
    v_and_b32 v25, s4, v68
    v_fma_f32 v26, v24, v124, v125
    v_fma_f32 v27, v25, v124, v125
    v_fma_f32 v24, v26, v88, v24
    v_fma_f32 v25, v27, v96, v25
    v_cvt_pk_bf16_f32 v16, v88, v96
    v_cvt_pk_bf16_f32 v17, v24, v25
    s_add_u32 s8, s52, 11534336
    buffer_store_dword v17, v7, s[40:43], s8 offen
    buffer_store_dword v16, v66, s[40:43], s55 offen offset:0
    v_add_f32 v89, v89, v93
    v_add_f32 v97, v97, v101
    v_lshlrev_b32 v24, 16, v69
    v_and_b32 v25, s4, v69
    v_fma_f32 v26, v24, v128, v129
    v_fma_f32 v27, v25, v128, v129
    v_fma_f32 v24, v26, v89, v24
    v_fma_f32 v25, v27, v97, v25
    v_cvt_pk_bf16_f32 v18, v89, v97
    v_cvt_pk_bf16_f32 v19, v24, v25
    s_add_u32 s8, s52, 11548672
    buffer_store_dword v19, v7, s[40:43], s8 offen
    buffer_store_dword v18, v66, s[40:43], s55 offen offset:64
    v_add_f32 v90, v90, v94
    v_add_f32 v98, v98, v102
    v_lshlrev_b32 v24, 16, v70
    v_and_b32 v25, s4, v70
    v_fma_f32 v26, v24, v132, v133
    v_fma_f32 v27, v25, v132, v133
    v_fma_f32 v24, v26, v90, v24
    v_fma_f32 v25, v27, v98, v25
    v_cvt_pk_bf16_f32 v20, v90, v98
    v_cvt_pk_bf16_f32 v21, v24, v25
    s_add_u32 s8, s52, 11563008
    buffer_store_dword v21, v7, s[40:43], s8 offen
    buffer_store_dword v20, v66, s[40:43], s55 offen offset:128
    v_add_f32 v91, v91, v95
    v_add_f32 v99, v99, v103
    v_lshlrev_b32 v24, 16, v71
    v_and_b32 v25, s4, v71
    v_fma_f32 v26, v24, v136, v137
    v_fma_f32 v27, v25, v136, v137
    v_fma_f32 v24, v26, v91, v24
    v_fma_f32 v25, v27, v99, v25
    v_cvt_pk_bf16_f32 v22, v91, v99
    v_cvt_pk_bf16_f32 v23, v24, v25
    s_add_u32 s8, s52, 11577344
    buffer_store_dword v23, v7, s[40:43], s8 offen
    buffer_store_dword v22, v66, s[40:43], s55 offen offset:192
    s_waitcnt lgkmcnt(0)
    v_add_f32 v104, v104, v108
    v_add_f32 v112, v112, v116
    v_lshlrev_b32 v24, 16, v72
    v_and_b32 v25, s4, v72
    v_fma_f32 v26, v24, v140, v141
    v_fma_f32 v27, v25, v140, v141
    v_fma_f32 v24, v26, v104, v24
    v_fma_f32 v25, v27, v112, v25
    v_cvt_pk_bf16_f32 v16, v104, v112
    v_cvt_pk_bf16_f32 v17, v24, v25
    s_add_u32 s8, s52, 11763712
    buffer_store_dword v17, v7, s[40:43], s8 offen
    buffer_store_dword v16, v66, s[40:43], s55 offen offset:1024
    v_add_f32 v105, v105, v109
    v_add_f32 v113, v113, v117
    v_lshlrev_b32 v24, 16, v73
    v_and_b32 v25, s4, v73
    v_fma_f32 v26, v24, v144, v145
    v_fma_f32 v27, v25, v144, v145
    v_fma_f32 v24, v26, v105, v24
    v_fma_f32 v25, v27, v113, v25
    v_cvt_pk_bf16_f32 v18, v105, v113
    v_cvt_pk_bf16_f32 v19, v24, v25
    s_add_u32 s8, s52, 11778048
    buffer_store_dword v19, v7, s[40:43], s8 offen
    buffer_store_dword v18, v66, s[40:43], s55 offen offset:1088
    v_add_f32 v106, v106, v110
    v_add_f32 v114, v114, v118
    v_lshlrev_b32 v24, 16, v74
    v_and_b32 v25, s4, v74
    v_fma_f32 v26, v24, v148, v149
    v_fma_f32 v27, v25, v148, v149
    v_fma_f32 v24, v26, v106, v24
    v_fma_f32 v25, v27, v114, v25
    v_cvt_pk_bf16_f32 v20, v106, v114
    v_cvt_pk_bf16_f32 v21, v24, v25
    s_add_u32 s8, s52, 11792384
    buffer_store_dword v21, v7, s[40:43], s8 offen
    buffer_store_dword v20, v66, s[40:43], s55 offen offset:1152
    v_add_f32 v107, v107, v111
    v_add_f32 v115, v115, v119
    v_lshlrev_b32 v24, 16, v75
    v_and_b32 v25, s4, v75
    v_fma_f32 v26, v24, v152, v153
    v_fma_f32 v27, v25, v152, v153
    v_fma_f32 v24, v26, v107, v24
    v_fma_f32 v25, v27, v115, v25
    v_cvt_pk_bf16_f32 v22, v107, v115
    v_cvt_pk_bf16_f32 v23, v24, v25
    s_add_u32 s8, s52, 11806720
    buffer_store_dword v23, v7, s[40:43], s8 offen
    buffer_store_dword v22, v66, s[40:43], s55 offen offset:1216
    s_branch L_kf_end
L_kf_pf:
    v_lshlrev_b32 v40, 7, v0
    s_getpc_b64 s[44:45]
L_kf_pc:
    s_mov_b32 s46, L_code_end-L_kf_pc
    s_mov_b32 s47, 0x20000
    buffer_load_dword v41, v40, s[44:47], 0 offen
    s_sub_u32 s5, s2, 224
    s_lshr_b32 s5, s5, 3
    s_lshl_b32 s5, s5, 2
    s_add_u32 s5, s5, s22
    s_mul_i32 s5, s5, 86016
    s_add_u32 s5, s5, 7340032
    v_lshlrev_b32 v40, 7, v2
    s_waitcnt vmcnt(0)
    buffer_load_dword v42, v40, s[40:43], s5 offen
    s_add_u32 s5, s5, 8192
    buffer_load_dword v43, v40, s[40:43], s5 offen
    s_add_u32 s5, s5, 8192
    buffer_load_dword v44, v40, s[40:43], s5 offen
    s_add_u32 s5, s5, 8192
    buffer_load_dword v45, v40, s[40:43], s5 offen
    s_add_u32 s5, s5, 8192
    buffer_load_dword v46, v40, s[40:43], s5 offen
    s_add_u32 s5, s5, 8192
    buffer_load_dword v47, v40, s[40:43], s5 offen
    s_add_u32 s5, s5, 8192
    buffer_load_dword v48, v40, s[40:43], s5 offen
    s_add_u32 s5, s5, 8192
    buffer_load_dword v49, v40, s[40:43], s5 offen
    s_add_u32 s5, s5, 8192
L_kf_end:
L_kf_done:
    s_endpgm
.globl km_kernel
.p2align 8
.type km_kernel,@function
km_kernel:
    s_cmp_ge_u32 s2, 256
    s_cbranch_scc1 L_km_done
    s_load_dwordx2 s[8:9], s[0:1], 88
    s_load_dwordx2 s[10:11], s[0:1], 72
    v_lshrrev_b32 v1, 6, v0
    v_and_b32 v2, 63, v0
    v_readfirstlane_b32 s22, v1
    s_and_b32 s12, s2, 7
    s_lshl_b32 s17, s12, 1
    s_lshr_b32 s16, s2, 7
    s_add_u32 s17, s17, s16
    s_bfe_u32 s16, s2, 0x40003
    s_lshr_b32 s14, s2, 3
    s_cmp_ge_u32 s14, 14
    s_cselect_b32 s18, 1, 0
    s_mul_i32 s19, s18, 14
    s_sub_u32 s19, s14, s19
    s_min_u32 s19, s19, 13
    s_lshl_b32 s14, s12, 1
    s_add_u32 s18, s18, s14
    v_lshlrev_b32 v3, 4, v2
    s_mov_b32 s20, 0
    s_mov_b32 s15, 6815744
    s_sub_u32 s21, 11, s22
    s_cmp_lt_u32 s22, 4
    s_cselect_b32 s21, s22, s21
    s_add_u32 s23, s21, 1
    s_lshr_b32 s23, s23, 1
    v_lshrrev_b32 v147, 4, v2
    v_and_b32 v146, 15, v2
    v_lshlrev_b32 v4, 2, v147
    v_sub_u32 v4, v146, v4
    v_cmp_eq_u32 s[60:61], 0, v4
    v_cmp_eq_u32 s[62:63], 1, v4
    v_cmp_eq_u32 s[64:65], 2, v4
    v_cmp_eq_u32 s[66:67], 3, v4
    v_cmp_eq_u32 s[68:69], 12, v146
    s_waitcnt lgkmcnt(0)
    s_mov_b32 s28, s8
    s_mov_b32 s29, s9
    s_mov_b32 s30, 32505856
    s_mov_b32 s31, 0x20000
    s_getreg_b32 s13, hwreg(HW_REG_XCC_ID)
    s_and_b32 s13, s13, 15
    s_add_u32 s13, s13, 1
    s_mov_b32 s14, 0
    s_cmp_lg_u32 s22, 7
    s_cbranch_scc1 L_km_noxc
    s_lshl_b32 s40, s2, 7
    s_add_u32 s40, s40, 6979584
    v_mov_b32 v4, s13
    v_mov_b32 v5, 0x40000000
    v_cmp_eq_u32 vcc, 0, v2
    s_nop 1
    v_cndmask_b32 v5, v5, 0, vcc
    buffer_store_dword v4, v5, s[28:31], s40 offen sc1
L_km_noxc:
    s_mul_i32 s26, s16, 6
    s_min_u32 s27, s22, 5
    s_add_u32 s26, s26, s27
    s_mul_i32 s26, s26, 896
    s_add_u32 s26, s26, 5242880
    v_mov_b32 v4, 0x40000000
    v_cmp_gt_u32 vcc, 56, v2
    s_lshl_b32 s27, s27, 6
    s_add_u32 s27, s27, 143168
    v_cndmask_b32 v4, v4, v3, vcc
    buffer_load_dwordx4 v[8:11], v4, s[28:31], s26 offen
    v_lshl_add_u32 v5, v146, 4, s27
    s_lshr_b32 s50, s22, 1
    s_mul_i32 s50, s50, 14336
    s_and_b32 s51, s22, 1
    s_lshl_b32 s52, s51, 10
    s_add_u32 s52, s52, s50
    s_add_u32 s52, s52, 12288
    s_lshl_b32 s51, s51, 11
    s_add_u32 s50, s50, s51
    s_mul_i32 s51, s16, 86016
    s_add_u32 s51, s51, 7368704
    s_add_u32 s53, s51, s50
    s_mov_b32 m0, s50
    s_add_u32 s50, s50, 4096
    buffer_load_dwordx4 v3, s[28:31], s53 offen lds
    buffer_load_dwordx4 v3, s[28:31], s53 offen offset:1024 lds
    s_add_u32 s53, s51, s50
    s_mov_b32 m0, s50
    s_add_u32 s50, s50, 4096
    buffer_load_dwordx4 v3, s[28:31], s53 offen lds
    buffer_load_dwordx4 v3, s[28:31], s53 offen offset:1024 lds
    s_lshl_b32 s34, s17, 3
    s_add_u32 s34, s34, s21
    s_mul_i32 s34, s34, 14336
    s_add_u32 s34, s34, s20
    s_add_u32 s34, s34, 11534336
    buffer_load_dwordx4 a[0:3], v3, s[28:31], s34 offen offset:0 sc1
    buffer_load_dwordx4 a[4:7], v3, s[28:31], s34 offen offset:1024 sc1
    buffer_load_dwordx4 a[8:11], v3, s[28:31], s34 offen offset:2048 sc1
    buffer_load_dwordx4 a[12:15], v3, s[28:31], s34 offen offset:3072 sc1
    s_add_u32 s34, s34, 4096
    buffer_load_dwordx4 a[16:19], v3, s[28:31], s34 offen offset:0 sc1
    s_waitcnt vmcnt(9)
    v_add_f32_dpp v8, v8, v8 row_shr:4 row_mask:0xf bank_mask:0xf bound_ctrl:0
    v_add_f32_dpp v9, v9, v9 row_shr:4 row_mask:0xf bank_mask:0xf bound_ctrl:0
    v_add_f32_dpp v10, v10, v10 row_shr:4 row_mask:0xf bank_mask:0xf bound_ctrl:0
    v_add_f32_dpp v11, v11, v11 row_shr:4 row_mask:0xf bank_mask:0xf bound_ctrl:0
    v_add_f32_dpp v8, v8, v8 row_shr:8 row_mask:0xf bank_mask:0xf bound_ctrl:0
    v_add_f32_dpp v9, v9, v9 row_shr:8 row_mask:0xf bank_mask:0xf bound_ctrl:0
    v_add_f32_dpp v10, v10, v10 row_shr:8 row_mask:0xf bank_mask:0xf bound_ctrl:0
    v_add_f32_dpp v11, v11, v11 row_shr:8 row_mask:0xf bank_mask:0xf bound_ctrl:0
    v_mov_b32 v12, v8
    v_mov_b32 v13, v9
    v_mov_b32 v14, v10
    v_mov_b32 v15, v11
    s_nop 1
    v_permlane16_swap_b32 v8, v12
    v_permlane16_swap_b32 v9, v13
    v_permlane16_swap_b32 v10, v14
    v_permlane16_swap_b32 v11, v15
    s_nop 1
    v_add_f32 v8, v8, v12
    v_add_f32 v9, v9, v13
    v_add_f32 v10, v10, v14
    v_add_f32 v11, v11, v15
    v_mov_b32 v12, v8
    v_mov_b32 v13, v9
    v_mov_b32 v14, v10
    v_mov_b32 v15, v11
    s_nop 1
    v_permlane32_swap_b32 v8, v12
    v_permlane32_swap_b32 v9, v13
    v_permlane32_swap_b32 v10, v14
    v_permlane32_swap_b32 v11, v15
    s_nop 1
    v_add_f32 v8, v8, v12
    v_add_f32 v9, v9, v13
    v_add_f32 v10, v10, v14
    v_add_f32 v11, v11, v15
    v_cmp_le_u32 vcc, 12, v146
    s_and_saveexec_b64 s[40:41], vcc
    ds_write_b128 v5, v[8:11]
    s_mov_b64 exec, s[40:41]
    s_waitcnt vmcnt(7) lgkmcnt(0)
    s_barrier
    s_branch L_km_gemm
L_km_layer:
    s_lshl_b32 s34, s17, 3
    s_add_u32 s34, s34, s21
    s_mul_i32 s34, s34, 14336
    s_add_u32 s34, s34, s20
    s_add_u32 s34, s34, 11534336
    buffer_load_dwordx4 a[0:3], v3, s[28:31], s34 offen offset:0 sc1
    buffer_load_dwordx4 a[4:7], v3, s[28:31], s34 offen offset:1024 sc1
    buffer_load_dwordx4 a[8:11], v3, s[28:31], s34 offen offset:2048 sc1
    buffer_load_dwordx4 a[12:15], v3, s[28:31], s34 offen offset:3072 sc1
    s_add_u32 s34, s34, 4096
    buffer_load_dwordx4 a[16:19], v3, s[28:31], s34 offen offset:0 sc1
L_km_gemm:
    s_setprio 2
    v_add_u32 v7, 90112, v3
    s_lshl_b32 s38, s22, 9
    s_add_u32 s38, s38, 139264
    v_lshl_add_u32 v144, v146, 3, s38
    v_lshl_add_u32 v145, v147, 5, s38
    v_mov_b32 v142, 0x3f803f80
    ds_read_b128 v[40:43], v3 offset:0
    ds_read_b128 v[44:47], v3 offset:14336
    ds_read_b128 v[48:51], v3 offset:28672
    ds_read_b128 v[52:55], v3 offset:43008
    ds_read_b128 v[56:59], v3 offset:1024
    ds_read_b128 v[60:63], v3 offset:15360
    ds_read_b128 v[64:67], v3 offset:29696
    ds_read_b128 v[68:71], v3 offset:44032
    s_cmp_lg_u32 s20, 0
    s_cbranch_scc1 L_km_ch0
    s_add_u32 s53, s51, s50
    s_mov_b32 m0, s50
    s_add_u32 s50, s50, 4096
    buffer_load_dwordx4 v3, s[28:31], s53 offen lds
    buffer_load_dwordx4 v3, s[28:31], s53 offen offset:1024 lds
L_km_ch0:
    buffer_load_dwordx4 a[20:23], v3, s[28:31], s34 offen offset:1024 sc1
    ds_read_b128 v[72:75], v3 offset:2048
    ds_read_b128 v[76:79], v3 offset:16384
    ds_read_b128 v[80:83], v3 offset:30720
    ds_read_b128 v[84:87], v3 offset:45056
    s_waitcnt vmcnt(5) lgkmcnt(8)
    v_mfma_f32_16x16x32_bf16 v[8:11], v[40:43], a[0:3], 0
    v_mfma_f32_16x16x32_bf16 v[12:15], v[44:47], a[0:3], 0
    v_mfma_f32_16x16x32_bf16 v[16:19], a[0:3], v[48:51], 0
    v_mfma_f32_16x16x32_bf16 v[20:23], a[0:3], v[52:55], 0
    v_mfma_f32_16x16x32_bf16 v[32:35], a[0:3], a[0:3], 0
    buffer_load_dwordx4 a[24:27], v3, s[28:31], s34 offen offset:2048 sc1
    ds_read_b128 v[40:43], v3 offset:3072
    ds_read_b128 v[44:47], v3 offset:17408
    ds_read_b128 v[48:51], v3 offset:31744
    ds_read_b128 v[52:55], v3 offset:46080
    s_waitcnt vmcnt(5) lgkmcnt(8)
    v_mfma_f32_16x16x32_bf16 v[8:11], v[56:59], a[4:7], v[8:11]
    v_mfma_f32_16x16x32_bf16 v[12:15], v[60:63], a[4:7], v[12:15]
    v_mfma_f32_16x16x32_bf16 v[16:19], a[4:7], v[64:67], v[16:19]
    v_mfma_f32_16x16x32_bf16 v[20:23], a[4:7], v[68:71], v[20:23]
    v_mfma_f32_16x16x32_bf16 v[32:35], a[4:7], a[4:7], v[32:35]
    s_cmp_lg_u32 s20, 0
    s_cbranch_scc1 L_km_ch2
    s_barrier
    s_add_u32 s53, s51, s52
    s_mov_b32 m0, s52
    s_nop 0
    buffer_load_dwordx4 v3, s[28:31], s53 offen lds
    s_lshr_b32 s26, s22, 2
    s_and_b32 s27, s22, 3
    s_lshl_b32 s27, s27, 12
    s_mul_i32 s40, s26, 14336
    s_add_u32 s40, s40, s27
    s_mul_i32 s41, s16, 86016
    s_add_u32 s40, s40, s41
    s_add_u32 s40, s40, 7340032
    s_mul_i32 s26, s26, 24576
    s_add_u32 s27, s27, s26
    s_add_u32 s27, s27, 90112
    s_mov_b32 m0, s27
    s_nop 0
    buffer_load_dwordx4 v3, s[28:31], s40 offen offset:0 lds
    buffer_load_dwordx4 v3, s[28:31], s40 offen offset:1024 lds
    buffer_load_dwordx4 v3, s[28:31], s40 offen offset:2048 lds
    buffer_load_dwordx4 v3, s[28:31], s40 offen offset:3072 lds
L_km_ch2:
    buffer_load_dwordx4 a[28:31], v3, s[28:31], s34 offen offset:3072 sc1
    ds_read_b128 v[56:59], v3 offset:4096
    ds_read_b128 v[60:63], v3 offset:18432
    ds_read_b128 v[64:67], v3 offset:32768
    ds_read_b128 v[68:71], v3 offset:47104
    s_waitcnt vmcnt(5) lgkmcnt(8)
    v_mfma_f32_16x16x32_bf16 v[8:11], v[72:75], a[8:11], v[8:11]
    v_mfma_f32_16x16x32_bf16 v[12:15], v[76:79], a[8:11], v[12:15]
    v_mfma_f32_16x16x32_bf16 v[16:19], a[8:11], v[80:83], v[16:19]
    v_mfma_f32_16x16x32_bf16 v[20:23], a[8:11], v[84:87], v[20:23]
    v_mfma_f32_16x16x32_bf16 v[32:35], a[8:11], a[8:11], v[32:35]
    s_add_u32 s34, s34, 4096
    buffer_load_dwordx4 a[32:35], v3, s[28:31], s34 offen offset:0 sc1
    ds_read_b128 v[72:75], v3 offset:5120
    ds_read_b128 v[76:79], v3 offset:19456
    ds_read_b128 v[80:83], v3 offset:33792
    ds_read_b128 v[84:87], v3 offset:48128
    s_waitcnt vmcnt(5) lgkmcnt(8)
    v_mfma_f32_16x16x32_bf16 v[8:11], v[40:43], a[12:15], v[8:11]
    v_mfma_f32_16x16x32_bf16 v[12:15], v[44:47], a[12:15], v[12:15]
    v_mfma_f32_16x16x32_bf16 v[16:19], a[12:15], v[48:51], v[16:19]
    v_mfma_f32_16x16x32_bf16 v[20:23], a[12:15], v[52:55], v[20:23]
    v_mfma_f32_16x16x32_bf16 v[32:35], a[12:15], a[12:15], v[32:35]
    buffer_load_dwordx4 a[36:39], v3, s[28:31], s34 offen offset:1024 sc1
    ds_read_b128 v[40:43], v3 offset:6144
    ds_read_b128 v[44:47], v3 offset:20480
    ds_read_b128 v[48:51], v3 offset:34816
    ds_read_b128 v[52:55], v3 offset:49152
    s_waitcnt vmcnt(5) lgkmcnt(8)
    v_mfma_f32_16x16x32_bf16 v[8:11], v[56:59], a[16:19], v[8:11]
    v_mfma_f32_16x16x32_bf16 v[12:15], v[60:63], a[16:19], v[12:15]
    v_mfma_f32_16x16x32_bf16 v[16:19], a[16:19], v[64:67], v[16:19]
    v_mfma_f32_16x16x32_bf16 v[20:23], a[16:19], v[68:71], v[20:23]
    v_mfma_f32_16x16x32_bf16 v[32:35], a[16:19], a[16:19], v[32:35]
    buffer_load_dwordx4 a[40:43], v3, s[28:31], s34 offen offset:2048 sc1
    ds_read_b128 v[56:59], v3 offset:7168
    ds_read_b128 v[60:63], v3 offset:21504
    ds_read_b128 v[64:67], v3 offset:35840
    ds_read_b128 v[68:71], v3 offset:50176
    s_waitcnt vmcnt(5) lgkmcnt(8)
    v_mfma_f32_16x16x32_bf16 v[8:11], v[72:75], a[20:23], v[8:11]
    v_mfma_f32_16x16x32_bf16 v[12:15], v[76:79], a[20:23], v[12:15]
    v_mfma_f32_16x16x32_bf16 v[16:19], a[20:23], v[80:83], v[16:19]
    v_mfma_f32_16x16x32_bf16 v[20:23], a[20:23], v[84:87], v[20:23]
    v_mfma_f32_16x16x32_bf16 v[32:35], a[20:23], a[20:23], v[32:35]
    s_cmp_lg_u32 s20, 0
    s_cbranch_scc1 L_km_ch6
    s_barrier
L_km_ch6:
    buffer_load_dwordx4 a[44:47], v3, s[28:31], s34 offen offset:3072 sc1
    ds_read_b128 v[72:75], v3 offset:8192
    ds_read_b128 v[76:79], v3 offset:22528
    ds_read_b128 v[80:83], v3 offset:36864
    ds_read_b128 v[84:87], v3 offset:51200
    s_waitcnt vmcnt(5) lgkmcnt(8)
    v_mfma_f32_16x16x32_bf16 v[8:11], v[40:43], a[24:27], v[8:11]
    v_mfma_f32_16x16x32_bf16 v[12:15], v[44:47], a[24:27], v[12:15]
    v_mfma_f32_16x16x32_bf16 v[16:19], a[24:27], v[48:51], v[16:19]
    v_mfma_f32_16x16x32_bf16 v[20:23], a[24:27], v[52:55], v[20:23]
    v_mfma_f32_16x16x32_bf16 v[32:35], a[24:27], a[24:27], v[32:35]
    s_add_u32 s34, s34, 4096
    buffer_load_dwordx4 a[48:51], v3, s[28:31], s34 offen offset:0 sc1
    ds_read_b128 v[40:43], v3 offset:9216
    ds_read_b128 v[44:47], v3 offset:23552
    ds_read_b128 v[48:51], v3 offset:37888
    ds_read_b128 v[52:55], v3 offset:52224
    s_waitcnt vmcnt(5) lgkmcnt(8)
    v_mfma_f32_16x16x32_bf16 v[8:11], v[56:59], a[28:31], v[8:11]
    v_mfma_f32_16x16x32_bf16 v[12:15], v[60:63], a[28:31], v[12:15]
    v_mfma_f32_16x16x32_bf16 v[16:19], a[28:31], v[64:67], v[16:19]
    v_mfma_f32_16x16x32_bf16 v[20:23], a[28:31], v[68:71], v[20:23]
    v_mfma_f32_16x16x32_bf16 v[32:35], a[28:31], a[28:31], v[32:35]
    buffer_load_dwordx4 a[52:55], v3, s[28:31], s34 offen offset:1024 sc1
    ds_read_b128 v[56:59], v3 offset:10240
    ds_read_b128 v[60:63], v3 offset:24576
    ds_read_b128 v[64:67], v3 offset:38912
    ds_read_b128 v[68:71], v3 offset:53248
    s_waitcnt vmcnt(5) lgkmcnt(8)
    v_mfma_f32_16x16x32_bf16 v[8:11], v[72:75], a[32:35], v[8:11]
    v_mfma_f32_16x16x32_bf16 v[12:15], v[76:79], a[32:35], v[12:15]
    v_mfma_f32_16x16x32_bf16 v[16:19], a[32:35], v[80:83], v[16:19]
    v_mfma_f32_16x16x32_bf16 v[20:23], a[32:35], v[84:87], v[20:23]
    v_mfma_f32_16x16x32_bf16 v[32:35], a[32:35], a[32:35], v[32:35]
    ds_read_b128 v[72:75], v3 offset:11264
    ds_read_b128 v[76:79], v3 offset:25600
    ds_read_b128 v[80:83], v3 offset:39936
    ds_read_b128 v[84:87], v3 offset:54272
    s_waitcnt vmcnt(4) lgkmcnt(8)
    v_mfma_f32_16x16x32_bf16 v[8:11], v[40:43], a[36:39], v[8:11]
    v_mfma_f32_16x16x32_bf16 v[12:15], v[44:47], a[36:39], v[12:15]
    v_mfma_f32_16x16x32_bf16 v[16:19], a[36:39], v[48:51], v[16:19]
    v_mfma_f32_16x16x32_bf16 v[20:23], a[36:39], v[52:55], v[20:23]
    v_mfma_f32_16x16x32_bf16 v[32:35], a[36:39], a[36:39], v[32:35]
    s_cmp_lg_u32 s20, 0
    s_cbranch_scc1 L_km_ch10
    s_barrier
L_km_ch10:
    ds_read_b128 v[40:43], v3 offset:12288
    ds_read_b128 v[44:47], v3 offset:26624
    ds_read_b128 v[48:51], v3 offset:40960
    ds_read_b128 v[52:55], v3 offset:55296
    s_waitcnt vmcnt(3) lgkmcnt(8)
    v_mfma_f32_16x16x32_bf16 v[8:11], v[56:59], a[40:43], v[8:11]
    v_mfma_f32_16x16x32_bf16 v[12:15], v[60:63], a[40:43], v[12:15]
    v_mfma_f32_16x16x32_bf16 v[16:19], a[40:43], v[64:67], v[16:19]
    v_mfma_f32_16x16x32_bf16 v[20:23], a[40:43], v[68:71], v[20:23]
    v_mfma_f32_16x16x32_bf16 v[32:35], a[40:43], a[40:43], v[32:35]
    ds_read_b128 v[56:59], v3 offset:13312
    ds_read_b128 v[60:63], v3 offset:27648
    ds_read_b128 v[64:67], v3 offset:41984
    ds_read_b128 v[68:71], v3 offset:56320
    s_waitcnt vmcnt(2) lgkmcnt(8)
    v_mfma_f32_16x16x32_bf16 v[8:11], v[72:75], a[44:47], v[8:11]
    v_mfma_f32_16x16x32_bf16 v[12:15], v[76:79], a[44:47], v[12:15]
    v_mfma_f32_16x16x32_bf16 v[16:19], a[44:47], v[80:83], v[16:19]
    v_mfma_f32_16x16x32_bf16 v[20:23], a[44:47], v[84:87], v[20:23]
    v_mfma_f32_16x16x32_bf16 v[32:35], a[44:47], a[44:47], v[32:35]
    s_waitcnt vmcnt(1) lgkmcnt(4)
    v_mfma_f32_16x16x32_bf16 v[8:11], v[40:43], a[48:51], v[8:11]
    v_mfma_f32_16x16x32_bf16 v[12:15], v[44:47], a[48:51], v[12:15]
    v_mfma_f32_16x16x32_bf16 v[16:19], a[48:51], v[48:51], v[16:19]
    v_mfma_f32_16x16x32_bf16 v[20:23], a[48:51], v[52:55], v[20:23]
    v_mfma_f32_16x16x32_bf16 v[32:35], a[48:51], a[48:51], v[32:35]
    s_waitcnt vmcnt(0) lgkmcnt(0)
    v_mfma_f32_16x16x32_bf16 v[8:11], v[56:59], a[52:55], v[8:11]
    v_mfma_f32_16x16x32_bf16 v[12:15], v[60:63], a[52:55], v[12:15]
    v_mfma_f32_16x16x32_bf16 v[16:19], a[52:55], v[64:67], v[16:19]
    v_mfma_f32_16x16x32_bf16 v[20:23], a[52:55], v[68:71], v[20:23]
    v_mfma_f32_16x16x32_bf16 v[32:35], a[52:55], a[52:55], v[32:35]
    v_lshlrev_b32 v4, 4, v147
    v_add_u32 v4, 143360, v4
    v_lshlrev_b32 v5, 2, v146
    v_add_u32 v5, 143360, v5
    ds_read_b128 v[96:99], v4 offset:0
    ds_read_b128 v[100:103], v4 offset:64
    ds_read_b128 v[104:107], v4 offset:128
    ds_read_b128 v[108:111], v4 offset:192
    ds_read_b32 v112, v5 offset:256
    ds_read_b32 v113, v5 offset:320
    ds_read_b128 v[40:43], v7 offset:0
    ds_read_b128 v[44:47], v7 offset:24576
    ds_read_b128 v[48:51], v7 offset:1024
    ds_read_b128 v[52:55], v7 offset:25600
    ds_read_b128 v[56:59], v7 offset:2048
    ds_read_b128 v[60:63], v7 offset:26624
    s_lshl_b32 s39, s21, 10
    s_add_u32 s40, s39, 106496
    v_add_u32 v4, s40, v3
    s_lshr_b32 s36, s22, 1
    s_lshl_b32 s37, s36, 11
    s_add_u32 s37, s39, 90112
    v_add_u32 v141, s37, v3
    s_lshl_b32 s26, s16, 17
    s_add_u32 s26, s26, s20
    s_lshl_b32 s27, s17, 13
    s_add_u32 s42, s26, s27
    s_add_u32 s42, s42, s39
    s_add_u32 s43, s42, 17825792
    s_add_u32 s42, s42, 15728640
    v_mov_b32 v116, v12
    v_cndmask_b32 v117, 0, v32, s[60:61]
    v_cndmask_b32 v117, v117, v33, s[62:63]
    v_cndmask_b32 v117, v117, v34, s[64:65]
    v_cndmask_b32 v117, v117, v35, s[66:67]
    v_mov_b32 v118, v116
    s_nop 1
    v_permlane32_swap_b32 v116, v118
    s_nop 1
    v_mov_b32 v116, v118
    s_nop 1
    v_permlane16_swap_b32 v118, v116
    s_nop 1
    v_mov_b32 v118, v117
    s_nop 1
    v_permlane16_swap_b32 v117, v118
    s_nop 1
    v_add_f32 v117, v117, v118
    v_mov_b32 v118, v117
    s_nop 1
    v_permlane32_swap_b32 v117, v118
    s_nop 1
    v_add_f32 v117, v117, v118
    v_mul_f32 v116, 0x3b124925, v116
    v_mul_f32 v117, 0x3b124925, v117
    v_fma_f32 v117, -v116, v116, v117
    v_max_f32 v117, 0, v117
    v_add_f32 v117, 0x3727c5ac, v117
    v_rsq_f32 v117, v117
    s_nop 0
    ds_write_b64 v144, v[116:117]
    ds_read_b128 v[124:127], v145
    ds_read_b128 v[128:131], v145 offset:16
    s_waitcnt lgkmcnt(3)
    v_fma_f32 v8, -v116, v104, v8
    v_fma_f32 v9, -v116, v105, v9
    v_fma_f32 v10, -v116, v106, v10
    v_fma_f32 v11, -v116, v107, v11
    v_fma_f32 v12, -v116, v108, v12
    v_fma_f32 v13, -v116, v109, v13
    v_fma_f32 v14, -v116, v110, v14
    v_fma_f32 v15, -v116, v111, v15
    v_mul_f32 v8, v8, v117
    v_mul_f32 v9, v9, v117
    v_mul_f32 v10, v10, v117
    v_mul_f32 v11, v11, v117
    v_mul_f32 v12, v12, v117
    v_mul_f32 v13, v13, v117
    v_mul_f32 v14, v14, v117
    v_mul_f32 v15, v15, v117
    v_cvt_pk_bf16_f32 v32, v8, v9
    v_cvt_pk_bf16_f32 v33, v10, v11
    v_cvt_pk_bf16_f32 v34, v12, v13
    v_cvt_pk_bf16_f32 v35, v14, v15
    ds_write_b128 v4, v[32:35]
    buffer_store_dwordx4 v[32:35], v3, s[28:31], s42 offen sc1
    s_waitcnt lgkmcnt(1)
    v_fma_f32 v16, -v124, v112, v16
    v_fma_f32 v17, -v126, v112, v17
    v_fma_f32 v18, -v128, v112, v18
    v_fma_f32 v19, -v130, v112, v19
    v_mul_f32 v16, v16, v125
    v_mul_f32 v17, v17, v127
    v_mul_f32 v18, v18, v129
    v_mul_f32 v19, v19, v131
    v_cvt_pk_bf16_f32 v36, v16, v17
    v_cvt_pk_bf16_f32 v37, v18, v19
    v_fma_f32 v20, -v124, v113, v20
    v_fma_f32 v21, -v126, v113, v21
    v_fma_f32 v22, -v128, v113, v22
    v_fma_f32 v23, -v130, v113, v23
    v_mul_f32 v20, v20, v125
    v_mul_f32 v21, v21, v127
    v_mul_f32 v22, v22, v129
    v_mul_f32 v23, v23, v131
    v_cvt_pk_bf16_f32 v38, v20, v21
    v_cvt_pk_bf16_f32 v39, v22, v23
    v_cndmask_b32 v38, v38, v142, s[68:69]
    v_cndmask_b32 v39, v39, v142, s[68:69]
    ds_write_b128 v4, v[36:39] offset:24576
    buffer_store_dwordx4 v[36:39], v3, s[28:31], s43 offen sc1
    s_setprio 0
    ds_read_b128 v[64:67], v7 offset:3072
    ds_read_b128 v[68:71], v7 offset:27648
    v_mfma_f32_16x16x32_bf16 v[8:11], v[40:43], a[0:3], 0
    v_mfma_f32_16x16x32_bf16 v[12:15], v[44:47], a[0:3], 0
    ds_read_b128 v[40:43], v7 offset:4096
    ds_read_b128 v[44:47], v7 offset:28672
    s_waitcnt lgkmcnt(6)
    v_mfma_f32_16x16x32_bf16 v[8:11], v[48:51], a[4:7], v[8:11]
    v_mfma_f32_16x16x32_bf16 v[12:15], v[52:55], a[4:7], v[12:15]
    ds_read_b128 v[48:51], v7 offset:5120
    ds_read_b128 v[52:55], v7 offset:29696
    s_waitcnt lgkmcnt(6)
    v_mfma_f32_16x16x32_bf16 v[8:11], v[56:59], a[8:11], v[8:11]
    v_mfma_f32_16x16x32_bf16 v[12:15], v[60:63], a[8:11], v[12:15]
    ds_read_b128 v[56:59], v7 offset:6144
    ds_read_b128 v[60:63], v7 offset:30720
    s_waitcnt lgkmcnt(6)
    v_mfma_f32_16x16x32_bf16 v[8:11], v[64:67], a[12:15], v[8:11]
    v_mfma_f32_16x16x32_bf16 v[12:15], v[68:71], a[12:15], v[12:15]
    ds_read_b128 v[64:67], v7 offset:7168
    ds_read_b128 v[68:71], v7 offset:31744
    s_waitcnt lgkmcnt(6)
    v_mfma_f32_16x16x32_bf16 v[8:11], v[40:43], a[16:19], v[8:11]
    v_mfma_f32_16x16x32_bf16 v[12:15], v[44:47], a[16:19], v[12:15]
    ds_read_b128 v[40:43], v7 offset:8192
    ds_read_b128 v[44:47], v7 offset:32768
    s_waitcnt lgkmcnt(6)
    v_mfma_f32_16x16x32_bf16 v[8:11], v[48:51], a[20:23], v[8:11]
    v_mfma_f32_16x16x32_bf16 v[12:15], v[52:55], a[20:23], v[12:15]
    ds_read_b128 v[48:51], v7 offset:9216
    ds_read_b128 v[52:55], v7 offset:33792
    s_waitcnt lgkmcnt(6)
    v_mfma_f32_16x16x32_bf16 v[8:11], v[56:59], a[24:27], v[8:11]
    v_mfma_f32_16x16x32_bf16 v[12:15], v[60:63], a[24:27], v[12:15]
    ds_read_b128 v[56:59], v7 offset:10240
    ds_read_b128 v[60:63], v7 offset:34816
    s_waitcnt lgkmcnt(6)
    v_mfma_f32_16x16x32_bf16 v[8:11], v[64:67], a[28:31], v[8:11]
    v_mfma_f32_16x16x32_bf16 v[12:15], v[68:71], a[28:31], v[12:15]
    ds_read_b128 v[64:67], v7 offset:11264
    ds_read_b128 v[68:71], v7 offset:35840
    s_waitcnt lgkmcnt(6)
    v_mfma_f32_16x16x32_bf16 v[8:11], v[40:43], a[32:35], v[8:11]
    v_mfma_f32_16x16x32_bf16 v[12:15], v[44:47], a[32:35], v[12:15]
    ds_read_b128 v[40:43], v7 offset:12288
    ds_read_b128 v[44:47], v7 offset:36864
    s_waitcnt lgkmcnt(6)
    v_mfma_f32_16x16x32_bf16 v[8:11], v[48:51], a[36:39], v[8:11]
    v_mfma_f32_16x16x32_bf16 v[12:15], v[52:55], a[36:39], v[12:15]
    ds_read_b128 v[48:51], v7 offset:13312
    ds_read_b128 v[52:55], v7 offset:37888
    s_waitcnt lgkmcnt(6)
    v_mfma_f32_16x16x32_bf16 v[8:11], v[56:59], a[40:43], v[8:11]
    v_mfma_f32_16x16x32_bf16 v[12:15], v[60:63], a[40:43], v[12:15]
    s_waitcnt lgkmcnt(4)
    v_mfma_f32_16x16x32_bf16 v[8:11], v[64:67], a[44:47], v[8:11]
    v_mfma_f32_16x16x32_bf16 v[12:15], v[68:71], a[44:47], v[12:15]
    s_waitcnt lgkmcnt(2)
    v_mfma_f32_16x16x32_bf16 v[8:11], v[40:43], a[48:51], v[8:11]
    v_mfma_f32_16x16x32_bf16 v[12:15], v[44:47], a[48:51], v[12:15]
    s_waitcnt lgkmcnt(0)
    v_mfma_f32_16x16x32_bf16 v[8:11], v[48:51], a[52:55], v[8:11]
    v_mfma_f32_16x16x32_bf16 v[12:15], v[52:55], a[52:55], v[12:15]
    s_lshl_b32 s47, s17, 4
    s_add_u32 s47, s47, s16
    s_waitcnt vmcnt(0) lgkmcnt(0)
    s_barrier
    s_cmp_lg_u32 s22, 7
    s_cbranch_scc1 L_pub_km_kernel_1
    s_lshl_b32 s40, s47, 7
    s_add_u32 s40, s40, s15
    v_mov_b32 v4, 1
    v_mov_b32 v5, 0x40000000
    v_cmp_eq_u32 vcc, 0, v2
    s_nop 1
    v_cndmask_b32 v5, v5, 0, vcc
    buffer_store_dword v4, v5, s[28:31], s40 offen sc1
L_pub_km_kernel_1:
    s_mov_b32 s48, s26
    s_mov_b32 s49, s27
    s_cmp_lg_u32 s20, 0
    s_cbranch_scc1 L_km_nowo
    s_lshl_b32 s26, s19, 15
    s_lshl_b32 s27, s22, 12
    s_add_u32 s26, s26, s27
    s_add_u32 s26, s26, 8716288
    s_add_u32 s27, s27, 57344
    s_mov_b32 m0, s27
    s_nop 0
    buffer_load_dwordx4 v3, s[28:31], s26 offen offset:0 lds
    buffer_load_dwordx4 v3, s[28:31], s26 offen offset:1024 lds
    buffer_load_dwordx4 v3, s[28:31], s26 offen offset:2048 lds
    buffer_load_dwordx4 v3, s[28:31], s26 offen offset:3072 lds
    v_and_b32 v148, 31, v2
    s_and_b32 s40, s2, 7
    v_lshl_add_u32 v148, v148, 3, s40
    v_lshlrev_b32 v148, 7, v148
    s_mov_b32 s40, 6979584
    buffer_load_dword v149, v148, s[28:31], s40 offen sc1
L_km_nowo:
    s_mov_b32 s26, s48
    s_mov_b32 s27, s49
    v_fma_f32 v8, -v116, v96, v8
    v_fma_f32 v9, -v116, v97, v9
    v_fma_f32 v10, -v116, v98, v10
    v_fma_f32 v11, -v116, v99, v11
    v_fma_f32 v12, -v116, v100, v12
    v_fma_f32 v13, -v116, v101, v13
    v_fma_f32 v14, -v116, v102, v14
    v_fma_f32 v15, -v116, v103, v15
    v_mul_f32 v8, v8, v117
    v_mul_f32 v9, v9, v117
    v_mul_f32 v10, v10, v117
    v_mul_f32 v11, v11, v117
    v_mul_f32 v12, v12, v117
    v_mul_f32 v13, v13, v117
    v_mul_f32 v14, v14, v117
    v_mul_f32 v15, v15, v117
    v_cvt_pk_bf16_f32 v120, v8, v9
    v_cvt_pk_bf16_f32 v121, v10, v11
    v_cvt_pk_bf16_f32 v122, v12, v13
    v_cvt_pk_bf16_f32 v123, v14, v15
    s_lshl_b32 s38, s17, 7
    s_lshl_b32 s40, s21, 4
    s_add_u32 s40, s40, s38
    s_sub_u32 s39, s40, 256
    v_add_u32 v9, s40, v146
    v_lshlrev_b32 v10, 2, v147
    v_add_u32 v10, s39, v10
    v_subrev_u32 v11, 255, v9
    v_max_i32 v11, 0, v11
    v_sub_u32 v11, v11, v10
    v_sub_u32 v9, v9, v10
    v_subrev_u32 v9, 256, v9
    v_mov_b32 v14, 0xf149f2ca
    v_cmp_ge_i32 s[44:45], 0, v11
    v_cmp_ge_i32 s[46:47], 1, v11
    v_cmp_ge_i32 s[48:49], 2, v11
    v_cmp_ge_i32 s[50:51], 3, v11
    v_cmp_le_i32 s[52:53], 0, v9
    v_cmp_le_i32 s[54:55], 1, v9
    v_cmp_le_i32 s[56:57], 2, v9
    v_cmp_le_i32 s[58:59], 3, v9
    v_mov_b32 v104, 0
    v_mov_b32 v105, 0
    v_mov_b32 v106, 0
    v_mov_b32 v107, 0
    v_mov_b32 v108, 0
    v_mov_b32 v109, 0
    v_mov_b32 v110, 0
    v_mov_b32 v111, 0
    v_mov_b32 v18, v14
    s_mov_b32 s41, 0x3e8b97f6
    s_cmp_gt_u32 s22, 1
    s_cbranch_scc1 L_km_stA
    s_sub_u32 s40, s17, 2
    s_add_u32 s40, s40, s22
    s_max_i32 s40, s40, 0
    s_lshl_b32 s40, s40, 4
    s_add_u32 s40, s40, s16
    s_lshl_b32 s40, s40, 7
    v_mov_b32 v4, s40
    s_mov_b32 s40, 0
L_km_hp:
    buffer_load_dword v5, v4, s[28:31], s15 offen sc1
    s_add_u32 s40, s40, 1
    s_waitcnt vmcnt(0)
    v_cmp_ne_u32 vcc, 1, v5
    s_cmp_gt_u32 s40, 0x80000
    s_cbranch_scc1 L_km_hd
    s_cbranch_vccz L_km_hd
    s_sleep 2
    s_branch L_km_hp
L_km_hd:
    s_lshl_b32 s35, s22, 13
    s_add_u32 s32, s27, s35
    s_sub_u32 s32, s32, 16384
    s_max_i32 s32, s32, 0
    s_add_u32 s32, s32, s26
    s_add_u32 s33, s32, 17825792
    s_add_u32 s32, s32, 15728640
    s_add_u32 s35, s35, 90112
    s_mov_b32 m0, s35
    s_add_u32 s35, s35, 4096
    buffer_load_dwordx4 v3, s[28:31], s32 offen offset:0 sc1 lds
    buffer_load_dwordx4 v3, s[28:31], s32 offen offset:1024 sc1 lds
    buffer_load_dwordx4 v3, s[28:31], s32 offen offset:2048 sc1 lds
    buffer_load_dwordx4 v3, s[28:31], s32 offen offset:3072 sc1 lds
    s_add_u32 s32, s32, 4096
    s_mov_b32 m0, s35
    s_add_u32 s35, s35, 20480
    buffer_load_dwordx4 v3, s[28:31], s32 offen offset:0 sc1 lds
    buffer_load_dwordx4 v3, s[28:31], s32 offen offset:1024 sc1 lds
    buffer_load_dwordx4 v3, s[28:31], s32 offen offset:2048 sc1 lds
    buffer_load_dwordx4 v3, s[28:31], s32 offen offset:3072 sc1 lds
    s_add_u32 s32, s32, 4096
    s_mov_b32 m0, s35
    s_add_u32 s35, s35, 4096
    buffer_load_dwordx4 v3, s[28:31], s33 offen offset:0 sc1 lds
    buffer_load_dwordx4 v3, s[28:31], s33 offen offset:1024 sc1 lds
    buffer_load_dwordx4 v3, s[28:31], s33 offen offset:2048 sc1 lds
    buffer_load_dwordx4 v3, s[28:31], s33 offen offset:3072 sc1 lds
    s_add_u32 s33, s33, 4096
    s_mov_b32 m0, s35
    s_add_u32 s35, s35, 20480
    buffer_load_dwordx4 v3, s[28:31], s33 offen offset:0 sc1 lds
    buffer_load_dwordx4 v3, s[28:31], s33 offen offset:1024 sc1 lds
    buffer_load_dwordx4 v3, s[28:31], s33 offen offset:2048 sc1 lds
    buffer_load_dwordx4 v3, s[28:31], s33 offen offset:3072 sc1 lds
    s_add_u32 s33, s33, 4096
    s_cmp_eq_u32 s22, 0
    s_cbranch_scc1 L_km_join2
L_km_stA:
    s_mov_b32 s24, s23
    ds_read_b128 a[0:3], v141 offset:15360
    ds_read_b128 a[4:7], v141 offset:16384
    ds_read_b128 a[8:11], v141 offset:13312
    ds_read_b128 a[12:15], v141 offset:14336
    ds_read_b128 a[16:19], v141 offset:11264
    ds_read_b128 a[20:23], v141 offset:12288
    ds_read_b128 a[24:27], v141 offset:9216
    ds_read_b128 a[28:31], v141 offset:10240
    s_waitcnt lgkmcnt(7)
    v_mfma_f32_16x16x32_bf16 v[84:87], a[0:3], v[120:123], 0
    s_waitcnt lgkmcnt(6)
    v_mfma_f32_16x16x32_bf16 v[88:91], a[4:7], v[120:123], 0
    s_cmp_le_u32 s24, 1
    s_cbranch_scc1 L_km_Am
    s_waitcnt lgkmcnt(5)
    v_mfma_f32_16x16x32_bf16 v[76:79], a[8:11], v[120:123], 0
    s_waitcnt lgkmcnt(4)
    v_mfma_f32_16x16x32_bf16 v[80:83], a[12:15], v[120:123], 0
    s_cmp_le_u32 s24, 2
    s_cbranch_scc1 L_km_Am
    s_waitcnt lgkmcnt(3)
    v_mfma_f32_16x16x32_bf16 v[68:71], a[16:19], v[120:123], 0
    s_waitcnt lgkmcnt(2)
    v_mfma_f32_16x16x32_bf16 v[72:75], a[20:23], v[120:123], 0
    s_cmp_le_u32 s24, 3
    s_cbranch_scc1 L_km_Am
    s_waitcnt lgkmcnt(1)
    v_mfma_f32_16x16x32_bf16 v[60:63], a[24:27], v[120:123], 0
    s_waitcnt lgkmcnt(0)
    v_mfma_f32_16x16x32_bf16 v[64:67], a[28:31], v[120:123], 0
L_km_Am:
    s_waitcnt lgkmcnt(0)
    ds_read_b64 a[0:1], v141 offset:39936
    ds_read_b64 a[2:3], v141 offset:40960
    ds_read_b64 a[4:5], v141 offset:39944
    ds_read_b64 a[6:7], v141 offset:40968
    ds_read_b64 a[8:9], v141 offset:37888
    ds_read_b64 a[10:11], v141 offset:38912
    ds_read_b64 a[12:13], v141 offset:37896
    ds_read_b64 a[14:15], v141 offset:38920
    ds_read_b64 a[16:17], v141 offset:35840
    ds_read_b64 a[18:19], v141 offset:36864
    ds_read_b64 a[20:21], v141 offset:35848
    ds_read_b64 a[22:23], v141 offset:36872
    v_mov_b32 v15, v18
    v_mov_b32 v16, v18
    v_cndmask_b32 v88, v14, v88, s[52:53]
    v_cndmask_b32 v89, v14, v89, s[54:55]
    v_cndmask_b32 v90, v14, v90, s[56:57]
    v_cndmask_b32 v91, v14, v91, s[58:59]
    v_max3_f32 v15, v84, v85, v15
    v_max3_f32 v16, v86, v87, v16
    v_max3_f32 v15, v88, v89, v15
    v_max3_f32 v16, v90, v91, v16
    s_cmp_le_u32 s24, 1
    s_cbranch_scc1 L_km_Ax
    v_max3_f32 v15, v76, v77, v15
    v_max3_f32 v16, v78, v79, v16
    v_max3_f32 v15, v80, v81, v15
    v_max3_f32 v16, v82, v83, v16
    s_cmp_le_u32 s24, 2
    s_cbranch_scc1 L_km_Ax
    v_max3_f32 v15, v68, v69, v15
    v_max3_f32 v16, v70, v71, v16
    v_max3_f32 v15, v72, v73, v15
    v_max3_f32 v16, v74, v75, v16
    s_cmp_le_u32 s24, 3
    s_cbranch_scc1 L_km_Ax
    v_max3_f32 v15, v60, v61, v15
    v_max3_f32 v16, v62, v63, v16
    v_max3_f32 v15, v64, v65, v15
    v_max3_f32 v16, v66, v67, v16
L_km_Ax:
    v_max_f32 v15, v15, v16
    v_mov_b32 v16, v15
    s_nop 1
    v_permlane16_swap_b32 v15, v16
    s_nop 1
    v_max_f32 v15, v15, v16
    v_mov_b32 v16, v15
    s_nop 1
    v_permlane32_swap_b32 v15, v16
    s_nop 1
    v_max_f32 v15, v15, v16
    v_mov_b32 v18, v15
    v_mul_f32 v15, s41, v15
    v_sub_f32 v15, 0, v15
    v_fma_f32 v84, v84, s41, v15
    v_fma_f32 v85, v85, s41, v15
    v_fma_f32 v86, v86, s41, v15
    v_fma_f32 v87, v87, s41, v15
    v_fma_f32 v88, v88, s41, v15
    v_fma_f32 v89, v89, s41, v15
    v_fma_f32 v90, v90, s41, v15
    v_fma_f32 v91, v91, s41, v15
    v_exp_f32 v84, v84
    v_exp_f32 v85, v85
    v_exp_f32 v86, v86
    v_exp_f32 v87, v87
    v_exp_f32 v88, v88
    v_exp_f32 v89, v89
    v_exp_f32 v90, v90
    v_exp_f32 v91, v91
    s_nop 0
    v_cvt_pk_bf16_f32 v96, v84, v85
    v_cvt_pk_bf16_f32 v97, v86, v87
    v_cvt_pk_bf16_f32 v98, v88, v89
    v_cvt_pk_bf16_f32 v99, v90, v91
    ds_read_b64 a[24:25], v141 offset:33792
    ds_read_b64 a[26:27], v141 offset:34816
    ds_read_b64 a[28:29], v141 offset:33800
    ds_read_b64 a[30:31], v141 offset:34824
    s_waitcnt lgkmcnt(12)
    s_nop 0
    v_mfma_f32_16x16x32_bf16 v[104:107], a[0:3], v[96:99], v[104:107]
    v_mfma_f32_16x16x32_bf16 v[108:111], a[4:7], v[96:99], v[108:111]
    s_cmp_le_u32 s24, 1
    s_cbranch_scc1 L_km_Ae
    v_fma_f32 v76, v76, s41, v15
    v_fma_f32 v77, v77, s41, v15
    v_fma_f32 v78, v78, s41, v15
    v_fma_f32 v79, v79, s41, v15
    v_fma_f32 v80, v80, s41, v15
    v_fma_f32 v81, v81, s41, v15
    v_fma_f32 v82, v82, s41, v15
    v_fma_f32 v83, v83, s41, v15
    v_exp_f32 v76, v76
    v_exp_f32 v77, v77
    v_exp_f32 v78, v78
    v_exp_f32 v79, v79
    v_exp_f32 v80, v80
    v_exp_f32 v81, v81
    v_exp_f32 v82, v82
    v_exp_f32 v83, v83
    s_nop 0
    v_cvt_pk_bf16_f32 v100, v76, v77
    v_cvt_pk_bf16_f32 v101, v78, v79
    v_cvt_pk_bf16_f32 v102, v80, v81
    v_cvt_pk_bf16_f32 v103, v82, v83
    s_waitcnt lgkmcnt(8)
    s_nop 0
    v_mfma_f32_16x16x32_bf16 v[104:107], a[8:11], v[100:103], v[104:107]
    v_mfma_f32_16x16x32_bf16 v[108:111], a[12:15], v[100:103], v[108:111]
    s_cmp_le_u32 s24, 2
    s_cbranch_scc1 L_km_Ae
    v_fma_f32 v68, v68, s41, v15
    v_fma_f32 v69, v69, s41, v15
    v_fma_f32 v70, v70, s41, v15
    v_fma_f32 v71, v71, s41, v15
    v_fma_f32 v72, v72, s41, v15
    v_fma_f32 v73, v73, s41, v15
    v_fma_f32 v74, v74, s41, v15
    v_fma_f32 v75, v75, s41, v15
    v_exp_f32 v68, v68
    v_exp_f32 v69, v69
    v_exp_f32 v70, v70
    v_exp_f32 v71, v71
    v_exp_f32 v72, v72
    v_exp_f32 v73, v73
    v_exp_f32 v74, v74
    v_exp_f32 v75, v75
    s_nop 0
    v_cvt_pk_bf16_f32 v96, v68, v69
    v_cvt_pk_bf16_f32 v97, v70, v71
    v_cvt_pk_bf16_f32 v98, v72, v73
    v_cvt_pk_bf16_f32 v99, v74, v75
    s_waitcnt lgkmcnt(4)
    s_nop 0
    v_mfma_f32_16x16x32_bf16 v[104:107], a[16:19], v[96:99], v[104:107]
    v_mfma_f32_16x16x32_bf16 v[108:111], a[20:23], v[96:99], v[108:111]
    s_cmp_le_u32 s24, 3
    s_cbranch_scc1 L_km_Ae
    v_fma_f32 v60, v60, s41, v15
    v_fma_f32 v61, v61, s41, v15
    v_fma_f32 v62, v62, s41, v15
    v_fma_f32 v63, v63, s41, v15
    v_fma_f32 v64, v64, s41, v15
    v_fma_f32 v65, v65, s41, v15
    v_fma_f32 v66, v66, s41, v15
    v_fma_f32 v67, v67, s41, v15
    v_exp_f32 v60, v60
    v_exp_f32 v61, v61
    v_exp_f32 v62, v62
    v_exp_f32 v63, v63
    v_exp_f32 v64, v64
    v_exp_f32 v65, v65
    v_exp_f32 v66, v66
    v_exp_f32 v67, v67
    s_nop 0
    v_cvt_pk_bf16_f32 v100, v60, v61
    v_cvt_pk_bf16_f32 v101, v62, v63
    v_cvt_pk_bf16_f32 v102, v64, v65
    v_cvt_pk_bf16_f32 v103, v66, v67
    s_waitcnt lgkmcnt(0)
    s_nop 0
    v_mfma_f32_16x16x32_bf16 v[104:107], a[24:27], v[100:103], v[104:107]
    v_mfma_f32_16x16x32_bf16 v[108:111], a[28:31], v[100:103], v[108:111]
L_km_Ae:
L_km_join2:
    s_sub_u32 s24, 9, s23
    s_add_u32 s15, s15, 32768
    s_waitcnt vmcnt(0) lgkmcnt(0)
    s_barrier
    ds_read_b128 a[0:3], v141 offset:0
    ds_read_b128 a[4:7], v141 offset:1024
    ds_read_b128 a[8:11], v141 offset:2048
    ds_read_b128 a[12:15], v141 offset:3072
    ds_read_b128 a[16:19], v141 offset:4096
    ds_read_b128 a[20:23], v141 offset:5120
    ds_read_b128 a[24:27], v141 offset:6144
    ds_read_b128 a[28:31], v141 offset:7168
    ds_read_b128 a[32:35], v141 offset:8192
    s_waitcnt lgkmcnt(8)
    v_mfma_f32_16x16x32_bf16 v[24:27], a[0:3], v[120:123], 0
    ds_read_b128 a[0:3], v141 offset:9216
    s_waitcnt lgkmcnt(8)
    v_mfma_f32_16x16x32_bf16 v[28:31], a[4:7], v[120:123], 0
    ds_read_b128 a[4:7], v141 offset:10240
    s_waitcnt lgkmcnt(8)
    v_mfma_f32_16x16x32_bf16 v[32:35], a[8:11], v[120:123], 0
    ds_read_b128 a[8:11], v141 offset:11264
    s_waitcnt lgkmcnt(8)
    v_mfma_f32_16x16x32_bf16 v[36:39], a[12:15], v[120:123], 0
    ds_read_b128 a[12:15], v141 offset:12288
    s_waitcnt lgkmcnt(8)
    v_mfma_f32_16x16x32_bf16 v[40:43], a[16:19], v[120:123], 0
    ds_read_b128 a[16:19], v141 offset:13312
    s_waitcnt lgkmcnt(8)
    v_mfma_f32_16x16x32_bf16 v[44:47], a[20:23], v[120:123], 0
    ds_read_b128 a[20:23], v141 offset:14336
    s_waitcnt lgkmcnt(8)
    v_mfma_f32_16x16x32_bf16 v[48:51], a[24:27], v[120:123], 0
    ds_read_b128 a[24:27], v141 offset:15360
    s_waitcnt lgkmcnt(8)
    v_mfma_f32_16x16x32_bf16 v[52:55], a[28:31], v[120:123], 0
    ds_read_b128 a[28:31], v141 offset:16384
    s_waitcnt lgkmcnt(8)
    v_mfma_f32_16x16x32_bf16 v[56:59], a[32:35], v[120:123], 0
    s_cmp_le_u32 s24, 5
    s_cbranch_scc1 L_km_Bm
    s_waitcnt lgkmcnt(7)
    v_mfma_f32_16x16x32_bf16 v[60:63], a[0:3], v[120:123], 0
    s_waitcnt lgkmcnt(6)
    v_mfma_f32_16x16x32_bf16 v[64:67], a[4:7], v[120:123], 0
    s_cmp_le_u32 s24, 6
    s_cbranch_scc1 L_km_Bm
    s_waitcnt lgkmcnt(5)
    v_mfma_f32_16x16x32_bf16 v[68:71], a[8:11], v[120:123], 0
    s_waitcnt lgkmcnt(4)
    v_mfma_f32_16x16x32_bf16 v[72:75], a[12:15], v[120:123], 0
    s_cmp_le_u32 s24, 7
    s_cbranch_scc1 L_km_Bm
    s_waitcnt lgkmcnt(3)
    v_mfma_f32_16x16x32_bf16 v[76:79], a[16:19], v[120:123], 0
    s_waitcnt lgkmcnt(2)
    v_mfma_f32_16x16x32_bf16 v[80:83], a[20:23], v[120:123], 0
    s_cmp_le_u32 s24, 8
    s_cbranch_scc1 L_km_Bm
    s_waitcnt lgkmcnt(1)
    v_mfma_f32_16x16x32_bf16 v[84:87], a[24:27], v[120:123], 0
    s_waitcnt lgkmcnt(0)
    v_mfma_f32_16x16x32_bf16 v[88:91], a[28:31], v[120:123], 0
L_km_Bm:
    s_waitcnt lgkmcnt(0)
    ds_read_b64 a[0:1], v141 offset:24576
    ds_read_b64 a[2:3], v141 offset:24576
    ds_read_b64 a[4:5], v141 offset:24584
    ds_read_b64 a[6:7], v141 offset:24584
    ds_read_b64 a[8:9], v141 offset:25600
    ds_read_b64 a[10:11], v141 offset:26624
    ds_read_b64 a[12:13], v141 offset:25608
    ds_read_b64 a[14:15], v141 offset:26632
    ds_read_b64 a[16:17], v141 offset:27648
    ds_read_b64 a[18:19], v141 offset:28672
    ds_read_b64 a[20:21], v141 offset:27656
    ds_read_b64 a[22:23], v141 offset:28680
    v_cndmask_b32 v24, v14, v24, s[44:45]
    v_cndmask_b32 v25, v14, v25, s[46:47]
    v_cndmask_b32 v26, v14, v26, s[48:49]
    v_cndmask_b32 v27, v14, v27, s[50:51]
    s_cmp_ge_i32 s39, -16
    s_cbranch_scc1 L_km_noneg
    v_mov_b32 v28, v14
    v_mov_b32 v29, v14
    v_mov_b32 v30, v14
    v_mov_b32 v31, v14
    s_cmp_ge_i32 s39, -32
    s_cbranch_scc1 L_km_noneg
    v_mov_b32 v32, v14
    v_mov_b32 v33, v14
    v_mov_b32 v34, v14
    v_mov_b32 v35, v14
    s_cmp_ge_i32 s39, -48
    s_cbranch_scc1 L_km_noneg
    v_mov_b32 v36, v14
    v_mov_b32 v37, v14
    v_mov_b32 v38, v14
    v_mov_b32 v39, v14
    s_cmp_ge_i32 s39, -64
    s_cbranch_scc1 L_km_noneg
    v_mov_b32 v40, v14
    v_mov_b32 v41, v14
    v_mov_b32 v42, v14
    v_mov_b32 v43, v14
    s_cmp_ge_i32 s39, -80
    s_cbranch_scc1 L_km_noneg
    v_mov_b32 v44, v14
    v_mov_b32 v45, v14
    v_mov_b32 v46, v14
    v_mov_b32 v47, v14
    s_cmp_ge_i32 s39, -96
    s_cbranch_scc1 L_km_noneg
    v_mov_b32 v48, v14
    v_mov_b32 v49, v14
    v_mov_b32 v50, v14
    v_mov_b32 v51, v14
    s_cmp_ge_i32 s39, -112
    s_cbranch_scc1 L_km_noneg
    v_mov_b32 v52, v14
    v_mov_b32 v53, v14
    v_mov_b32 v54, v14
    v_mov_b32 v55, v14
    s_cmp_ge_i32 s39, -128
    s_cbranch_scc1 L_km_noneg
    v_mov_b32 v56, v14
    v_mov_b32 v57, v14
    v_mov_b32 v58, v14
    v_mov_b32 v59, v14
    s_cmp_ge_i32 s39, -144
    s_cbranch_scc1 L_km_noneg
    v_mov_b32 v60, v14
    v_mov_b32 v61, v14
    v_mov_b32 v62, v14
    v_mov_b32 v63, v14
    s_cmp_ge_i32 s39, -160
    s_cbranch_scc1 L_km_noneg
    v_mov_b32 v64, v14
    v_mov_b32 v65, v14
    v_mov_b32 v66, v14
    v_mov_b32 v67, v14
    s_cmp_ge_i32 s39, -176
    s_cbranch_scc1 L_km_noneg
    v_mov_b32 v68, v14
    v_mov_b32 v69, v14
    v_mov_b32 v70, v14
    v_mov_b32 v71, v14
    s_cmp_ge_i32 s39, -192
    s_cbranch_scc1 L_km_noneg
    v_mov_b32 v72, v14
    v_mov_b32 v73, v14
    v_mov_b32 v74, v14
    v_mov_b32 v75, v14
    s_cmp_ge_i32 s39, -208
    s_cbranch_scc1 L_km_noneg
    v_mov_b32 v76, v14
    v_mov_b32 v77, v14
    v_mov_b32 v78, v14
    v_mov_b32 v79, v14
    s_cmp_ge_i32 s39, -224
    s_cbranch_scc1 L_km_noneg
    v_mov_b32 v80, v14
    v_mov_b32 v81, v14
    v_mov_b32 v82, v14
    v_mov_b32 v83, v14
    s_cmp_ge_i32 s39, -240
    s_cbranch_scc1 L_km_noneg
    v_mov_b32 v84, v14
    v_mov_b32 v85, v14
    v_mov_b32 v86, v14
    v_mov_b32 v87, v14
L_km_noneg:
    v_mov_b32 v15, v18
    v_mov_b32 v16, v18
    v_max3_f32 v15, v24, v25, v15
    v_max3_f32 v16, v26, v27, v16
    v_max3_f32 v15, v28, v29, v15
    v_max3_f32 v16, v30, v31, v16
    v_max3_f32 v15, v32, v33, v15
    v_max3_f32 v16, v34, v35, v16
    v_max3_f32 v15, v36, v37, v15
    v_max3_f32 v16, v38, v39, v16
    v_max3_f32 v15, v40, v41, v15
    v_max3_f32 v16, v42, v43, v16
    v_max3_f32 v15, v44, v45, v15
    v_max3_f32 v16, v46, v47, v16
    v_max3_f32 v15, v48, v49, v15
    v_max3_f32 v16, v50, v51, v16
    v_max3_f32 v15, v52, v53, v15
    v_max3_f32 v16, v54, v55, v16
    v_max3_f32 v15, v56, v57, v15
    v_max3_f32 v16, v58, v59, v16
    s_cmp_le_u32 s24, 5
    s_cbranch_scc1 L_km_Bx
    v_max3_f32 v15, v60, v61, v15
    v_max3_f32 v16, v62, v63, v16
    v_max3_f32 v15, v64, v65, v15
    v_max3_f32 v16, v66, v67, v16
    s_cmp_le_u32 s24, 6
    s_cbranch_scc1 L_km_Bx
    v_max3_f32 v15, v68, v69, v15
    v_max3_f32 v16, v70, v71, v16
    v_max3_f32 v15, v72, v73, v15
    v_max3_f32 v16, v74, v75, v16
    s_cmp_le_u32 s24, 7
    s_cbranch_scc1 L_km_Bx
    v_max3_f32 v15, v76, v77, v15
    v_max3_f32 v16, v78, v79, v16
    v_max3_f32 v15, v80, v81, v15
    v_max3_f32 v16, v82, v83, v16
    s_cmp_le_u32 s24, 8
    s_cbranch_scc1 L_km_Bx
    v_cndmask_b32 v88, v14, v88, s[52:53]
    v_cndmask_b32 v89, v14, v89, s[54:55]
    v_cndmask_b32 v90, v14, v90, s[56:57]
    v_cndmask_b32 v91, v14, v91, s[58:59]
    v_max3_f32 v15, v84, v85, v15
    v_max3_f32 v16, v86, v87, v16
    v_max3_f32 v15, v88, v89, v15
    v_max3_f32 v16, v90, v91, v16
L_km_Bx:
    v_max_f32 v15, v15, v16
    v_mov_b32 v16, v15
    s_nop 1
    v_permlane16_swap_b32 v15, v16
    s_nop 1
    v_max_f32 v15, v15, v16
    v_mov_b32 v16, v15
    s_nop 1
    v_permlane32_swap_b32 v15, v16
    s_nop 1
    v_max_f32 v15, v15, v16
    v_sub_f32 v16, v18, v15
    v_mul_f32 v16, s41, v16
    v_exp_f32 v16, v16
    s_nop 0
    v_mul_f32 v104, v104, v16
    v_mul_f32 v105, v105, v16
    v_mul_f32 v106, v106, v16
    v_mul_f32 v107, v107, v16
    v_mul_f32 v108, v108, v16
    v_mul_f32 v109, v109, v16
    v_mul_f32 v110, v110, v16
    v_mul_f32 v111, v111, v16
    v_mov_b32 v18, v15
    v_mul_f32 v15, s41, v15
    v_sub_f32 v15, 0, v15
    v_fma_f32 v24, v24, s41, v15
    v_fma_f32 v25, v25, s41, v15
    v_fma_f32 v26, v26, s41, v15
    v_fma_f32 v27, v27, s41, v15
    v_exp_f32 v24, v24
    v_exp_f32 v25, v25
    v_exp_f32 v26, v26
    v_exp_f32 v27, v27
    s_nop 0
    v_cvt_pk_bf16_f32 v96, v24, v25
    v_cvt_pk_bf16_f32 v97, v26, v27
    v_mov_b32 v98, 0
    v_mov_b32 v99, 0
    ds_read_b64 a[24:25], v141 offset:29696
    ds_read_b64 a[26:27], v141 offset:30720
    ds_read_b64 a[28:29], v141 offset:29704
    ds_read_b64 a[30:31], v141 offset:30728
    s_waitcnt lgkmcnt(12)
    s_nop 0
    v_mfma_f32_16x16x32_bf16 v[104:107], a[0:3], v[96:99], v[104:107]
    v_mfma_f32_16x16x32_bf16 v[108:111], a[4:7], v[96:99], v[108:111]
    v_fma_f32 v28, v28, s41, v15
    v_fma_f32 v29, v29, s41, v15
    v_fma_f32 v30, v30, s41, v15
    v_fma_f32 v31, v31, s41, v15
    v_fma_f32 v32, v32, s41, v15
    v_fma_f32 v33, v33, s41, v15
    v_fma_f32 v34, v34, s41, v15
    v_fma_f32 v35, v35, s41, v15
    v_exp_f32 v28, v28
    v_exp_f32 v29, v29
    v_exp_f32 v30, v30
    v_exp_f32 v31, v31
    v_exp_f32 v32, v32
    v_exp_f32 v33, v33
    v_exp_f32 v34, v34
    v_exp_f32 v35, v35
    s_nop 0
    v_cvt_pk_bf16_f32 v100, v28, v29
    v_cvt_pk_bf16_f32 v101, v30, v31
    v_cvt_pk_bf16_f32 v102, v32, v33
    v_cvt_pk_bf16_f32 v103, v34, v35
    ds_read_b64 a[32:33], v141 offset:31744
    ds_read_b64 a[34:35], v141 offset:32768
    ds_read_b64 a[36:37], v141 offset:31752
    ds_read_b64 a[38:39], v141 offset:32776
    s_waitcnt lgkmcnt(12)
    s_nop 0
    v_mfma_f32_16x16x32_bf16 v[104:107], a[8:11], v[100:103], v[104:107]
    v_mfma_f32_16x16x32_bf16 v[108:111], a[12:15], v[100:103], v[108:111]
    v_fma_f32 v36, v36, s41, v15
    v_fma_f32 v37, v37, s41, v15
    v_fma_f32 v38, v38, s41, v15
    v_fma_f32 v39, v39, s41, v15
    v_fma_f32 v40, v40, s41, v15
    v_fma_f32 v41, v41, s41, v15
    v_fma_f32 v42, v42, s41, v15
    v_fma_f32 v43, v43, s41, v15
    v_exp_f32 v36, v36
    v_exp_f32 v37, v37
    v_exp_f32 v38, v38
    v_exp_f32 v39, v39
    v_exp_f32 v40, v40
    v_exp_f32 v41, v41
    v_exp_f32 v42, v42
    v_exp_f32 v43, v43
    s_nop 0
    v_cvt_pk_bf16_f32 v96, v36, v37
    v_cvt_pk_bf16_f32 v97, v38, v39
    v_cvt_pk_bf16_f32 v98, v40, v41
    v_cvt_pk_bf16_f32 v99, v42, v43
    ds_read_b64 a[40:41], v141 offset:33792
    ds_read_b64 a[42:43], v141 offset:34816
    ds_read_b64 a[44:45], v141 offset:33800
    ds_read_b64 a[46:47], v141 offset:34824
    s_waitcnt lgkmcnt(12)
    s_nop 0
    v_mfma_f32_16x16x32_bf16 v[104:107], a[16:19], v[96:99], v[104:107]
    v_mfma_f32_16x16x32_bf16 v[108:111], a[20:23], v[96:99], v[108:111]
    v_fma_f32 v44, v44, s41, v15
    v_fma_f32 v45, v45, s41, v15
    v_fma_f32 v46, v46, s41, v15
    v_fma_f32 v47, v47, s41, v15
    v_fma_f32 v48, v48, s41, v15
    v_fma_f32 v49, v49, s41, v15
    v_fma_f32 v50, v50, s41, v15
    v_fma_f32 v51, v51, s41, v15
    v_exp_f32 v44, v44
    v_exp_f32 v45, v45
    v_exp_f32 v46, v46
    v_exp_f32 v47, v47
    v_exp_f32 v48, v48
    v_exp_f32 v49, v49
    v_exp_f32 v50, v50
    v_exp_f32 v51, v51
    s_nop 0
    v_cvt_pk_bf16_f32 v100, v44, v45
    v_cvt_pk_bf16_f32 v101, v46, v47
    v_cvt_pk_bf16_f32 v102, v48, v49
    v_cvt_pk_bf16_f32 v103, v50, v51
    ds_read_b64 a[0:1], v141 offset:35840
    ds_read_b64 a[2:3], v141 offset:36864
    ds_read_b64 a[4:5], v141 offset:35848
    ds_read_b64 a[6:7], v141 offset:36872
    s_waitcnt lgkmcnt(12)
    s_nop 0
    v_mfma_f32_16x16x32_bf16 v[104:107], a[24:27], v[100:103], v[104:107]
    v_mfma_f32_16x16x32_bf16 v[108:111], a[28:31], v[100:103], v[108:111]
    v_fma_f32 v52, v52, s41, v15
    v_fma_f32 v53, v53, s41, v15
    v_fma_f32 v54, v54, s41, v15
    v_fma_f32 v55, v55, s41, v15
    v_fma_f32 v56, v56, s41, v15
    v_fma_f32 v57, v57, s41, v15
    v_fma_f32 v58, v58, s41, v15
    v_fma_f32 v59, v59, s41, v15
    v_exp_f32 v52, v52
    v_exp_f32 v53, v53
    v_exp_f32 v54, v54
    v_exp_f32 v55, v55
    v_exp_f32 v56, v56
    v_exp_f32 v57, v57
    v_exp_f32 v58, v58
    v_exp_f32 v59, v59
    s_nop 0
    v_cvt_pk_bf16_f32 v96, v52, v53
    v_cvt_pk_bf16_f32 v97, v54, v55
    v_cvt_pk_bf16_f32 v98, v56, v57
    v_cvt_pk_bf16_f32 v99, v58, v59
    ds_read_b64 a[8:9], v141 offset:37888
    ds_read_b64 a[10:11], v141 offset:38912
    ds_read_b64 a[12:13], v141 offset:37896
    ds_read_b64 a[14:15], v141 offset:38920
    s_waitcnt lgkmcnt(12)
    s_nop 0
    v_mfma_f32_16x16x32_bf16 v[104:107], a[32:35], v[96:99], v[104:107]
    v_mfma_f32_16x16x32_bf16 v[108:111], a[36:39], v[96:99], v[108:111]
    s_cmp_le_u32 s24, 5
    s_cbranch_scc1 L_km_Be
    v_fma_f32 v60, v60, s41, v15
    v_fma_f32 v61, v61, s41, v15
    v_fma_f32 v62, v62, s41, v15
    v_fma_f32 v63, v63, s41, v15
    v_fma_f32 v64, v64, s41, v15
    v_fma_f32 v65, v65, s41, v15
    v_fma_f32 v66, v66, s41, v15
    v_fma_f32 v67, v67, s41, v15
    v_exp_f32 v60, v60
    v_exp_f32 v61, v61
    v_exp_f32 v62, v62
    v_exp_f32 v63, v63
    v_exp_f32 v64, v64
    v_exp_f32 v65, v65
    v_exp_f32 v66, v66
    v_exp_f32 v67, v67
    s_nop 0
    v_cvt_pk_bf16_f32 v100, v60, v61
    v_cvt_pk_bf16_f32 v101, v62, v63
    v_cvt_pk_bf16_f32 v102, v64, v65
    v_cvt_pk_bf16_f32 v103, v66, v67
    ds_read_b64 a[16:17], v141 offset:39936
    ds_read_b64 a[18:19], v141 offset:40960
    ds_read_b64 a[20:21], v141 offset:39944
    ds_read_b64 a[22:23], v141 offset:40968
    s_waitcnt lgkmcnt(12)
    s_nop 0
    v_mfma_f32_16x16x32_bf16 v[104:107], a[40:43], v[100:103], v[104:107]
    v_mfma_f32_16x16x32_bf16 v[108:111], a[44:47], v[100:103], v[108:111]
    s_cmp_le_u32 s24, 6
    s_cbranch_scc1 L_km_Be
    v_fma_f32 v68, v68, s41, v15
    v_fma_f32 v69, v69, s41, v15
    v_fma_f32 v70, v70, s41, v15
    v_fma_f32 v71, v71, s41, v15
    v_fma_f32 v72, v72, s41, v15
    v_fma_f32 v73, v73, s41, v15
    v_fma_f32 v74, v74, s41, v15
    v_fma_f32 v75, v75, s41, v15
    v_exp_f32 v68, v68
    v_exp_f32 v69, v69
    v_exp_f32 v70, v70
    v_exp_f32 v71, v71
    v_exp_f32 v72, v72
    v_exp_f32 v73, v73
    v_exp_f32 v74, v74
    v_exp_f32 v75, v75
    s_nop 0
    v_cvt_pk_bf16_f32 v96, v68, v69
    v_cvt_pk_bf16_f32 v97, v70, v71
    v_cvt_pk_bf16_f32 v98, v72, v73
    v_cvt_pk_bf16_f32 v99, v74, v75
    s_waitcnt lgkmcnt(8)
    s_nop 0
    v_mfma_f32_16x16x32_bf16 v[104:107], a[0:3], v[96:99], v[104:107]
    v_mfma_f32_16x16x32_bf16 v[108:111], a[4:7], v[96:99], v[108:111]
    s_cmp_le_u32 s24, 7
    s_cbranch_scc1 L_km_Be
    v_fma_f32 v76, v76, s41, v15
    v_fma_f32 v77, v77, s41, v15
    v_fma_f32 v78, v78, s41, v15
    v_fma_f32 v79, v79, s41, v15
    v_fma_f32 v80, v80, s41, v15
    v_fma_f32 v81, v81, s41, v15
    v_fma_f32 v82, v82, s41, v15
    v_fma_f32 v83, v83, s41, v15
    v_exp_f32 v76, v76
    v_exp_f32 v77, v77
    v_exp_f32 v78, v78
    v_exp_f32 v79, v79
    v_exp_f32 v80, v80
    v_exp_f32 v81, v81
    v_exp_f32 v82, v82
    v_exp_f32 v83, v83
    s_nop 0
    v_cvt_pk_bf16_f32 v100, v76, v77
    v_cvt_pk_bf16_f32 v101, v78, v79
    v_cvt_pk_bf16_f32 v102, v80, v81
    v_cvt_pk_bf16_f32 v103, v82, v83
    s_waitcnt lgkmcnt(4)
    s_nop 0
    v_mfma_f32_16x16x32_bf16 v[104:107], a[8:11], v[100:103], v[104:107]
    v_mfma_f32_16x16x32_bf16 v[108:111], a[12:15], v[100:103], v[108:111]
    s_cmp_le_u32 s24, 8
    s_cbranch_scc1 L_km_Be
    v_fma_f32 v84, v84, s41, v15
    v_fma_f32 v85, v85, s41, v15
    v_fma_f32 v86, v86, s41, v15
    v_fma_f32 v87, v87, s41, v15
    v_fma_f32 v88, v88, s41, v15
    v_fma_f32 v89, v89, s41, v15
    v_fma_f32 v90, v90, s41, v15
    v_fma_f32 v91, v91, s41, v15
    v_exp_f32 v84, v84
    v_exp_f32 v85, v85
    v_exp_f32 v86, v86
    v_exp_f32 v87, v87
    v_exp_f32 v88, v88
    v_exp_f32 v89, v89
    v_exp_f32 v90, v90
    v_exp_f32 v91, v91
    s_nop 0
    v_cvt_pk_bf16_f32 v96, v84, v85
    v_cvt_pk_bf16_f32 v97, v86, v87
    v_cvt_pk_bf16_f32 v98, v88, v89
    v_cvt_pk_bf16_f32 v99, v90, v91
    s_waitcnt lgkmcnt(0)
    s_nop 0
    v_mfma_f32_16x16x32_bf16 v[104:107], a[16:19], v[96:99], v[104:107]
    v_mfma_f32_16x16x32_bf16 v[108:111], a[20:23], v[96:99], v[108:111]
L_km_Be:
    s_waitcnt lgkmcnt(0)
    s_lshl_b32 s36, s17, 3
    s_add_u32 s36, s36, s21
    s_lshl_b32 s36, s36, 4
    s_add_u32 s36, s36, s16
    s_lshl_b32 s36, s36, 10
    s_add_u32 s36, s36, s20
    s_add_u32 s36, s36, 19922944
    s_lshl_b32 s47, s17, 4
    s_add_u32 s47, s47, s16
    s_nop 2
    v_mov_b32 v17, v108
    v_mov_b32 v16, v17
    s_nop 1
    v_permlane32_swap_b32 v17, v16
    s_nop 1
    v_mov_b32 v17, v16
    s_nop 1
    v_permlane16_swap_b32 v16, v17
    s_nop 1
    v_rcp_f32 v17, v17
    s_nop 0
    v_mul_f32 v104, v104, v17
    v_mul_f32 v105, v105, v17
    v_mul_f32 v106, v106, v17
    v_mul_f32 v107, v107, v17
    v_mul_f32 v108, v108, v17
    v_mul_f32 v109, v109, v17
    v_mul_f32 v110, v110, v17
    v_mul_f32 v111, v111, v17
    v_cvt_pk_bf16_f32 v96, v104, v105
    v_cvt_pk_bf16_f32 v97, v106, v107
    v_cvt_pk_bf16_f32 v98, v108, v109
    v_cvt_pk_bf16_f32 v99, v110, v111
    buffer_store_dwordx4 v[96:99], v3, s[28:31], s36 offen sc1
    s_mov_b32 s40, 6979584
    s_mov_b32 s41, 0
L_km_mp:
    v_cmp_eq_u32 vcc, 0, v149
    s_add_u32 s41, s41, 1
    s_cmp_gt_u32 s41, 0x80000
    s_cbranch_scc1 L_km_md
    s_cbranch_vccz L_km_md
    buffer_load_dword v149, v148, s[28:31], s40 offen sc1
    s_waitcnt vmcnt(0)
    s_branch L_km_mp
L_km_md:
    v_cmp_ne_u32 vcc, s13, v149
    s_cmp_eq_u64 vcc, 0
    s_cselect_b32 s14, 1, 0
    s_waitcnt vmcnt(0)
    s_barrier
    s_cmp_lg_u32 s22, 7
    s_cbranch_scc1 L_pub_km_kernel_2
    s_lshl_b32 s40, s47, 7
    s_add_u32 s40, s40, s15
    v_mov_b32 v4, 1
    v_mov_b32 v5, 0x40000000
    v_cmp_eq_u32 vcc, 0, v2
    s_nop 1
    v_cndmask_b32 v5, v5, 0, vcc
    s_cmp_eq_u32 s14, 1
    s_cbranch_scc1 L_sl_km_kernel_3
    buffer_store_dword v4, v5, s[28:31], s40 offen sc1
    s_branch L_sj_km_kernel_4
L_sl_km_kernel_3:
    buffer_store_dword v4, v5, s[28:31], s40 offen
L_sj_km_kernel_4:
L_pub_km_kernel_2:
    s_cmp_lg_u32 s20, 0
    s_cbranch_scc1 L_km_nowq
    s_lshr_b32 s26, s22, 2
    s_and_b32 s27, s22, 3
    s_lshl_b32 s27, s27, 12
    s_mul_i32 s40, s26, 14336
    s_add_u32 s40, s40, s27
    s_mul_i32 s41, s16, 86016
    s_add_u32 s40, s40, s41
    s_add_u32 s40, s40, 7340032
    s_mul_i32 s26, s26, 24576
    s_add_u32 s27, s27, s26
    s_add_u32 s27, s27, 90112
    s_mov_b32 m0, s27
    s_nop 0
    buffer_load_dwordx4 v3, s[28:31], s40 offen offset:0 lds
    buffer_load_dwordx4 v3, s[28:31], s40 offen offset:1024 lds
    buffer_load_dwordx4 v3, s[28:31], s40 offen offset:2048 lds
    buffer_load_dwordx4 v3, s[28:31], s40 offen offset:3072 lds
L_km_nowq:
    s_cmp_ge_u32 s2, 224
    s_cbranch_scc1 L_km_p3skip
    s_lshl_b32 s36, s18, 3
    s_add_u32 s36, s36, s22
    s_mul_i32 s38, s36, 14
    s_mov_b32 s39, s19
    s_add_u32 s38, s38, s39
    s_lshl_b32 s38, s38, 10
    s_add_u32 s40, s38, s20
    s_add_u32 s40, s40, 11534336
    buffer_load_dwordx4 v[64:67], v3, s[28:31], s40 offen sc1
    s_movk_i32 s41, 16640
    v_mul_lo_u32 v4, v147, s41
    v_lshl_add_u32 v4, v146, 2, v4
    s_mul_i32 s41, s39, 133120
    s_lshl_b32 s42, s36, 6
    s_add_u32 s41, s41, s42
    s_add_u32 s41, s41, 9437184
    s_add_u32 s42, s41, 8320
    s_add_u32 s43, s41, 66560
    s_add_u32 s44, s41, 74880
    buffer_load_dword v72, v4, s[28:31], s41 offen
    buffer_load_dword v73, v4, s[28:31], s42 offen
    buffer_load_dword v74, v4, s[28:31], s43 offen
    buffer_load_dword v75, v4, s[28:31], s44 offen
    s_cmp_lg_u32 s22, 7
    s_cbranch_scc1 L_pd_km_kernel_6
    s_lshl_b32 s41, s18, 4
    v_add_u32 v4, s41, v146
    v_lshlrev_b32 v4, 7, v4
    s_mov_b32 s40, 0
L_poll_km_kernel_5:
    buffer_load_dword v5, v4, s[28:31], s15 offen sc1
    s_add_u32 s40, s40, 1
    s_waitcnt vmcnt(0)
    v_cmp_ne_u32 vcc, 1, v5
    s_cmp_gt_u32 s40, 0x80000
    s_cbranch_scc1 L_pd_km_kernel_6
    s_cbranch_vccz L_pd_km_kernel_6
    s_sleep 2
    s_branch L_poll_km_kernel_5
L_pd_km_kernel_6:
    s_waitcnt vmcnt(0)
    s_barrier
    s_add_u32 s15, s15, 32768
    s_lshl_b32 s26, s36, 14
    s_add_u32 s26, s26, s20
    s_add_u32 s26, s26, 19922944
    v_add_u32 v5, 57344, v3
    s_mov_b32 s42, 0xffff0000
    buffer_load_dwordx4 a[0:3], v3, s[28:31], s26 offen offset:0 sc1
    buffer_load_dwordx4 a[4:7], v3, s[28:31], s26 offen offset:1024 sc1
    buffer_load_dwordx4 a[8:11], v3, s[28:31], s26 offen offset:2048 sc1
    buffer_load_dwordx4 a[12:15], v3, s[28:31], s26 offen offset:3072 sc1
    s_add_u32 s26, s26, 4096
    buffer_load_dwordx4 a[16:19], v3, s[28:31], s26 offen offset:0 sc1
    buffer_load_dwordx4 a[20:23], v3, s[28:31], s26 offen offset:1024 sc1
    ds_read_b128 v[24:27], v5 offset:0
    ds_read_b128 v[28:31], v5 offset:16384
    ds_read_b128 v[32:35], v5 offset:1024
    ds_read_b128 v[36:39], v5 offset:17408
    buffer_load_dwordx4 a[24:27], v3, s[28:31], s26 offen offset:2048 sc1
    ds_read_b128 v[40:43], v5 offset:2048
    ds_read_b128 v[44:47], v5 offset:18432
    s_waitcnt vmcnt(6) lgkmcnt(4)
    v_mfma_f32_16x16x32_bf16 v[8:11], v[24:27], a[0:3], 0
    v_mfma_f32_16x16x32_bf16 v[12:15], v[28:31], a[0:3], 0
    buffer_load_dwordx4 a[28:31], v3, s[28:31], s26 offen offset:3072 sc1
    ds_read_b128 v[24:27], v5 offset:3072
    ds_read_b128 v[28:31], v5 offset:19456
    s_waitcnt vmcnt(6) lgkmcnt(4)
    v_mfma_f32_16x16x32_bf16 v[8:11], v[32:35], a[4:7], v[8:11]
    v_mfma_f32_16x16x32_bf16 v[12:15], v[36:39], a[4:7], v[12:15]
    s_add_u32 s26, s26, 4096
    buffer_load_dwordx4 a[0:3], v3, s[28:31], s26 offen offset:0 sc1
    ds_read_b128 v[32:35], v5 offset:4096
    ds_read_b128 v[36:39], v5 offset:20480
    s_waitcnt vmcnt(6) lgkmcnt(4)
    v_mfma_f32_16x16x32_bf16 v[8:11], v[40:43], a[8:11], v[8:11]
    v_mfma_f32_16x16x32_bf16 v[12:15], v[44:47], a[8:11], v[12:15]
    buffer_load_dwordx4 a[4:7], v3, s[28:31], s26 offen offset:1024 sc1
    ds_read_b128 v[40:43], v5 offset:5120
    ds_read_b128 v[44:47], v5 offset:21504
    s_waitcnt vmcnt(6) lgkmcnt(4)
    v_mfma_f32_16x16x32_bf16 v[8:11], v[24:27], a[12:15], v[8:11]
    v_mfma_f32_16x16x32_bf16 v[12:15], v[28:31], a[12:15], v[12:15]
    buffer_load_dwordx4 a[8:11], v3, s[28:31], s26 offen offset:2048 sc1
    ds_read_b128 v[24:27], v5 offset:6144
    ds_read_b128 v[28:31], v5 offset:22528
    s_waitcnt vmcnt(6) lgkmcnt(4)
    v_mfma_f32_16x16x32_bf16 v[8:11], v[32:35], a[16:19], v[8:11]
    v_mfma_f32_16x16x32_bf16 v[12:15], v[36:39], a[16:19], v[12:15]
    buffer_load_dwordx4 a[12:15], v3, s[28:31], s26 offen offset:3072 sc1
    ds_read_b128 v[32:35], v5 offset:7168
    ds_read_b128 v[36:39], v5 offset:23552
    s_waitcnt vmcnt(6) lgkmcnt(4)
    v_mfma_f32_16x16x32_bf16 v[8:11], v[40:43], a[20:23], v[8:11]
    v_mfma_f32_16x16x32_bf16 v[12:15], v[44:47], a[20:23], v[12:15]
    s_add_u32 s26, s26, 4096
    buffer_load_dwordx4 a[16:19], v3, s[28:31], s26 offen offset:0 sc1
    ds_read_b128 v[40:43], v5 offset:8192
    ds_read_b128 v[44:47], v5 offset:24576
    s_waitcnt vmcnt(6) lgkmcnt(4)
    v_mfma_f32_16x16x32_bf16 v[8:11], v[24:27], a[24:27], v[8:11]
    v_mfma_f32_16x16x32_bf16 v[12:15], v[28:31], a[24:27], v[12:15]
    buffer_load_dwordx4 a[20:23], v3, s[28:31], s26 offen offset:1024 sc1
    ds_read_b128 v[24:27], v5 offset:9216
    ds_read_b128 v[28:31], v5 offset:25600
    s_waitcnt vmcnt(6) lgkmcnt(4)
    v_mfma_f32_16x16x32_bf16 v[8:11], v[32:35], a[28:31], v[8:11]
    v_mfma_f32_16x16x32_bf16 v[12:15], v[36:39], a[28:31], v[12:15]
    buffer_load_dwordx4 a[24:27], v3, s[28:31], s26 offen offset:2048 sc1
    ds_read_b128 v[32:35], v5 offset:10240
    ds_read_b128 v[36:39], v5 offset:26624
    s_waitcnt vmcnt(6) lgkmcnt(4)
    v_mfma_f32_16x16x32_bf16 v[8:11], v[40:43], a[0:3], v[8:11]
    v_mfma_f32_16x16x32_bf16 v[12:15], v[44:47], a[0:3], v[12:15]
    buffer_load_dwordx4 a[28:31], v3, s[28:31], s26 offen offset:3072 sc1
    ds_read_b128 v[40:43], v5 offset:11264
    ds_read_b128 v[44:47], v5 offset:27648
    s_waitcnt vmcnt(6) lgkmcnt(4)
    v_mfma_f32_16x16x32_bf16 v[8:11], v[24:27], a[4:7], v[8:11]
    v_mfma_f32_16x16x32_bf16 v[12:15], v[28:31], a[4:7], v[12:15]
    ds_read_b128 v[24:27], v5 offset:12288
    ds_read_b128 v[28:31], v5 offset:28672
    s_waitcnt vmcnt(5) lgkmcnt(4)
    v_mfma_f32_16x16x32_bf16 v[8:11], v[32:35], a[8:11], v[8:11]
    v_mfma_f32_16x16x32_bf16 v[12:15], v[36:39], a[8:11], v[12:15]
    ds_read_b128 v[32:35], v5 offset:13312
    ds_read_b128 v[36:39], v5 offset:29696
    s_waitcnt vmcnt(4) lgkmcnt(4)
    v_mfma_f32_16x16x32_bf16 v[8:11], v[40:43], a[12:15], v[8:11]
    v_mfma_f32_16x16x32_bf16 v[12:15], v[44:47], a[12:15], v[12:15]
    ds_read_b128 v[40:43], v5 offset:14336
    ds_read_b128 v[44:47], v5 offset:30720
    s_waitcnt vmcnt(3) lgkmcnt(4)
    v_mfma_f32_16x16x32_bf16 v[8:11], v[24:27], a[16:19], v[8:11]
    v_mfma_f32_16x16x32_bf16 v[12:15], v[28:31], a[16:19], v[12:15]
    ds_read_b128 v[24:27], v5 offset:15360
    ds_read_b128 v[28:31], v5 offset:31744
    s_waitcnt vmcnt(2) lgkmcnt(4)
    v_mfma_f32_16x16x32_bf16 v[8:11], v[32:35], a[20:23], v[8:11]
    v_mfma_f32_16x16x32_bf16 v[12:15], v[36:39], a[20:23], v[12:15]
    s_waitcnt vmcnt(1) lgkmcnt(2)
    v_mfma_f32_16x16x32_bf16 v[8:11], v[40:43], a[24:27], v[8:11]
    v_mfma_f32_16x16x32_bf16 v[12:15], v[44:47], a[24:27], v[12:15]
    s_waitcnt vmcnt(0) lgkmcnt(0)
    v_mfma_f32_16x16x32_bf16 v[8:11], v[24:27], a[28:31], v[8:11]
    v_mfma_f32_16x16x32_bf16 v[12:15], v[28:31], a[28:31], v[12:15]
    s_nop 7
    v_lshlrev_b32 v28, 16, v64
    v_and_b32 v29, s42, v64
    v_add_f32 v8, v8, v28
    v_add_f32 v9, v9, v29
    v_lshlrev_b32 v28, 16, v65
    v_and_b32 v29, s42, v65
    v_add_f32 v10, v10, v28
    v_add_f32 v11, v11, v29
    v_lshlrev_b32 v28, 16, v66
    v_and_b32 v29, s42, v66
    v_add_f32 v12, v12, v28
    v_add_f32 v13, v13, v29
    v_lshlrev_b32 v28, 16, v67
    v_and_b32 v29, s42, v67
    v_add_f32 v14, v14, v28
    v_add_f32 v15, v15, v29
    s_cmp_lg_u32 s20, 0
    s_cbranch_scc1 L_km_final
    v_add_f32 v88, v8, v9
    v_mul_f32 v89, v8, v8
    v_fma_f32 v89, v9, v9, v89
    v_add_f32 v88, v88, v10
    v_fma_f32 v89, v10, v10, v89
    v_add_f32 v88, v88, v11
    v_fma_f32 v89, v11, v11, v89
    v_add_f32 v88, v88, v12
    v_fma_f32 v89, v12, v12, v89
    v_add_f32 v88, v88, v13
    v_fma_f32 v89, v13, v13, v89
    v_add_f32 v88, v88, v14
    v_fma_f32 v89, v14, v14, v89
    v_add_f32 v88, v88, v15
    v_fma_f32 v89, v15, v15, v89
    v_mov_b32 v90, v88
    v_mov_b32 v91, v89
    s_nop 1
    v_permlane16_swap_b32 v88, v90
    v_permlane16_swap_b32 v89, v91
    s_nop 1
    v_add_f32 v88, v88, v90
    v_add_f32 v89, v89, v91
    v_mov_b32 v90, v88
    v_mov_b32 v91, v89
    s_nop 1
    v_permlane32_swap_b32 v88, v90
    v_permlane32_swap_b32 v89, v91
    s_nop 1
    v_add_f32 v88, v88, v90
    v_add_f32 v89, v89, v91
    v_lshlrev_b32 v6, 3, v146
    v_lshl_add_u32 v93, v147, 7, v6
    v_mov_b32 v7, 0x40000000
    v_cmp_eq_u32 vcc, 0, v147
    s_lshl_b32 s44, s36, 11
    s_add_u32 s44, s44, 6356992
    s_lshl_b32 s43, s39, 7
    s_add_u32 s43, s43, s44
    v_cndmask_b32 v6, v7, v6, vcc
    v_cmp_gt_u32 s[46:47], 2, v147
    s_cmp_eq_u32 s14, 1
    s_cbranch_scc1 L_sl_km_kernel_7
    buffer_store_dwordx2 v[88:89], v6, s[28:31], s43 offen sc1
    s_branch L_sj_km_kernel_8
L_sl_km_kernel_7:
    buffer_store_dwordx2 v[88:89], v6, s[28:31], s43 offen
L_sj_km_kernel_8:
    s_mov_b32 s45, 0
L_km_poll3:
    s_sleep 4
    buffer_load_dwordx2 v[24:25], v93, s[28:31], s44 offen sc1
    buffer_load_dwordx2 v[26:27], v93, s[28:31], s44 offen offset:512 sc1
    buffer_load_dwordx2 v[28:29], v93, s[28:31], s44 offen offset:1024 sc1
    buffer_load_dwordx2 v[30:31], v93, s[28:31], s44 offen offset:1536 sc1
    s_add_u32 s45, s45, 1
    s_waitcnt vmcnt(0)
    v_cndmask_b32 v30, 0, v30, s[46:47]
    v_cndmask_b32 v31, 0, v31, s[46:47]
    v_max3_u32 v32, v24, v25, v26
    v_max3_u32 v33, v27, v28, v29
    v_max3_u32 v32, v30, v31, v32
    v_max_u32 v32, v32, v33
    v_cmp_eq_u32 vcc, -1, v32
    s_cmp_gt_u32 s45, 0x40000
    s_cbranch_scc1 L_km_pd3
    s_cbranch_vccnz L_km_poll3
L_km_pd3:
    v_add_f32 v24, v24, v26
    v_add_f32 v25, v25, v27
    v_add_f32 v28, v28, v30
    v_add_f32 v29, v29, v31
    v_add_f32 v24, v24, v28
    v_add_f32 v25, v25, v29
    v_mov_b32 v28, v24
    v_mov_b32 v29, v25
    s_nop 1
    v_permlane16_swap_b32 v24, v28
    v_permlane16_swap_b32 v25, v29
    s_nop 1
    v_add_f32 v24, v24, v28
    v_add_f32 v25, v25, v29
    v_mov_b32 v28, v24
    v_mov_b32 v29, v25
    s_nop 1
    v_permlane32_swap_b32 v24, v28
    v_permlane32_swap_b32 v25, v29
    s_nop 1
    v_add_f32 v24, v24, v28
    v_add_f32 v25, v25, v29
    v_mul_f32 v24, 0x3b124925, v24
    v_mul_f32 v25, 0x3b124925, v25
    v_fma_f32 v25, -v24, v24, v25
    v_max_f32 v25, 0, v25
    v_add_f32 v25, 0x3727c5ac, v25
    v_rsq_f32 v25, v25
    s_nop 0
    v_mul_f32 v24, v24, v25
    v_lshlrev_b32 v28, 16, v72
    v_and_b32 v29, s42, v72
    v_fma_f32 v30, v8, v25, -v24
    v_fma_f32 v31, v9, v25, -v24
    v_fma_f32 v8, v30, v28, v8
    v_fma_f32 v9, v31, v29, v9
    v_cvt_pk_bf16_f32 v80, v8, v9
    v_lshlrev_b32 v28, 16, v73
    v_and_b32 v29, s42, v73
    v_fma_f32 v30, v10, v25, -v24
    v_fma_f32 v31, v11, v25, -v24
    v_fma_f32 v10, v30, v28, v10
    v_fma_f32 v11, v31, v29, v11
    v_cvt_pk_bf16_f32 v81, v10, v11
    v_lshlrev_b32 v28, 16, v74
    v_and_b32 v29, s42, v74
    v_fma_f32 v30, v12, v25, -v24
    v_fma_f32 v31, v13, v25, -v24
    v_fma_f32 v12, v30, v28, v12
    v_fma_f32 v13, v31, v29, v13
    v_cvt_pk_bf16_f32 v82, v12, v13
    v_lshlrev_b32 v28, 16, v75
    v_and_b32 v29, s42, v75
    v_fma_f32 v30, v14, v25, -v24
    v_fma_f32 v31, v15, v25, -v24
    v_fma_f32 v14, v30, v28, v14
    v_fma_f32 v15, v31, v29, v15
    v_cvt_pk_bf16_f32 v83, v14, v15
    s_add_u32 s40, s38, 22020096
    buffer_store_dwordx4 v[80:83], v3, s[28:31], s40 offen sc1
    s_lshl_b32 s47, s18, 4
    s_add_u32 s47, s47, s19
    s_waitcnt vmcnt(0)
    s_barrier
    s_cmp_lg_u32 s22, 7
    s_cbranch_scc1 L_pub_km_kernel_9
    s_lshl_b32 s40, s47, 7
    s_add_u32 s40, s40, s15
    v_mov_b32 v4, 1
    v_mov_b32 v5, 0x40000000
    v_cmp_eq_u32 vcc, 0, v2
    s_nop 1
    v_cndmask_b32 v5, v5, 0, vcc
    s_cmp_eq_u32 s14, 1
    s_cbranch_scc1 L_sl_km_kernel_10
    buffer_store_dword v4, v5, s[28:31], s40 offen sc1
    s_branch L_sj_km_kernel_11
L_sl_km_kernel_10:
    buffer_store_dword v4, v5, s[28:31], s40 offen
L_sj_km_kernel_11:
L_pub_km_kernel_9:
    s_branch L_km_next
L_km_p3skip:
    s_cmp_lg_u32 s20, 0
    s_cbranch_scc1 L_km_end
    s_add_u32 s15, s15, 32768
L_km_next:
    s_cmp_lg_u32 s22, 7
    s_cbranch_scc1 L_pd_km_kernel_13
    v_min_u32 v4, 13, v146
    s_lshl_b32 s41, s17, 4
    v_add_u32 v4, s41, v4
    v_lshlrev_b32 v4, 7, v4
    s_mov_b32 s40, 0
L_poll_km_kernel_12:
    buffer_load_dword v5, v4, s[28:31], s15 offen sc1
    s_add_u32 s40, s40, 1
    s_waitcnt vmcnt(0)
    v_cmp_ne_u32 vcc, 1, v5
    s_cmp_gt_u32 s40, 0x80000
    s_cbranch_scc1 L_pd_km_kernel_13
    s_cbranch_vccz L_pd_km_kernel_13
    s_sleep 2
    s_branch L_poll_km_kernel_12
L_pd_km_kernel_13:
    s_waitcnt vmcnt(0)
    s_barrier
    s_add_u32 s15, s15, 32768
    s_mov_b32 s20, 10485760
    s_branch L_km_layer
L_km_final:
    v_cvt_pk_bf16_f32 v80, v8, v9
    v_cvt_pk_bf16_f32 v81, v10, v11
    v_cvt_pk_bf16_f32 v82, v12, v13
    v_cvt_pk_bf16_f32 v83, v14, v15
    s_mov_b32 s44, s10
    s_mov_b32 s45, s11
    s_mov_b32 s46, 1835008
    s_mov_b32 s47, 0x20000
    s_movk_i32 s40, 896
    v_mul_lo_u32 v6, v146, s40
    v_lshl_add_u32 v6, v147, 3, v6
    s_mul_i32 s40, s36, 14336
    s_lshl_b32 s41, s39, 6
    s_add_u32 s40, s40, s41
    buffer_store_dwordx2 v[80:81], v6, s[44:47], s40 offen
    buffer_store_dwordx2 v[82:83], v6, s[44:47], s40 offen offset:32
L_km_end:
L_km_done:
    s_endpgm
L_code_end:
.section .rodata,"a"
.p2align 6
.amdhsa_kernel kf_kernel
  .amdhsa_next_free_vgpr 432
  .amdhsa_next_free_sgpr 72
  .amdhsa_accum_offset 176
  .amdhsa_group_segment_fixed_size 0
  .amdhsa_kernarg_size 96
  .amdhsa_user_sgpr_count 2
  .amdhsa_user_sgpr_kernarg_segment_ptr 1
  .amdhsa_system_sgpr_workgroup_id_x 1
.end_amdhsa_kernel
.p2align 6
.amdhsa_kernel km_kernel
  .amdhsa_next_free_vgpr 216
  .amdhsa_next_free_sgpr 72
  .amdhsa_accum_offset 160
  .amdhsa_group_segment_fixed_size 0
  .amdhsa_kernarg_size 96
  .amdhsa_user_sgpr_count 2
  .amdhsa_user_sgpr_kernarg_segment_ptr 1
  .amdhsa_system_sgpr_workgroup_id_x 1
.end_amdhsa_kernel
```
